```python
import torch

def _softmax(x, axis=-1):
    return torch.softmax(x, dim=axis)
def _gelu(x):
    return torch.nn.functional.gelu(x, approximate="tanh")
def _silu(x):
    return torch.nn.functional.silu(x)
def _sigmoid(x):
    return torch.sigmoid(x)
def _layernorm(x, axis=-1, eps=1e-5):
    m = x.mean(dim=axis, keepdim=True)
    v = x.var(dim=axis, keepdim=True, unbiased=False)
    return (x - m) / torch.sqrt(v + eps)
def _scatter_add(tgt, idx, src, axis=0):
    return tgt.clone().index_add_(axis, idx, src)
def _segment_sum(src, seg, n):
    out = torch.zeros((n,) + src.shape[1:], dtype=src.dtype)
    return out.index_add_(0, seg, src)
def _pad(x, pw):
    flat = tuple(v for pair in reversed(pw) for v in pair)
    return torch.nn.functional.pad(x, flat)

kernel_name = 'parallel_sum__spectral_gfnet__mixer_token_mlp__prompt'

def setup_inputs():

    _w = (lambda a: (lambda t: t.to(torch.bfloat16) if t.is_floating_point() else t)(torch.as_tensor(a)))
    def _A_setup():
        B, S, D = 1, 2048, 512
        Df = D // 2 + 1
        return {
            "x": _w((lambda *s: torch.randn(*s, dtype=torch.bfloat16) * 0.05)(B, S, D)),
            "w_r": _w((lambda *s: torch.randn(*s, dtype=torch.bfloat16) * 0.2)(S, Df) * 0.02),
            "w_i": _w((lambda *s: torch.randn(*s, dtype=torch.bfloat16) * 0.2)(S, Df) * 0.02),
        }
    _A_in = _A_setup()

    def _B_setup():
        B, S, D, F = 1, 2048, 512, 1792
        return {
            "x": _w((lambda *s: torch.randn(*s, dtype=torch.bfloat16) * 0.05)(B, S, D)),
            "w1": _w((lambda *s: torch.randn(*s, dtype=torch.bfloat16) * 0.4)(S, F) * (S ** -0.5)),
            "b1": _w((lambda *s: torch.randn(*s, dtype=torch.bfloat16) * 3.2)(F) * 0.02),
            "w2": _w((lambda *s: torch.randn(*s, dtype=torch.bfloat16) * 0.1)(F, S) * (F ** -0.5)),
            "b2": _w((lambda *s: torch.randn(*s, dtype=torch.bfloat16) * 0.4)(S) * 0.02),
        }
    _B_in = _B_setup()

    return {
        "A_x": _A_in["x"],
        "A_w_r": _A_in["w_r"],
        "A_w_i": _A_in["w_i"],
        "B_x": _B_in["x"],
        "B_w1": _B_in["w1"],
        "B_b1": _B_in["b1"],
        "B_w2": _B_in["w2"],
        "B_b2": _B_in["b2"],
    }

def reference(A_x, A_w_r, A_w_i, B_x, B_w1, B_b1, B_w2, B_b2):
    def _A_ref(x, w_r, w_i):
        B, S, D = x.shape
        X = (lambda x, axes=(-2,-1): torch.fft.rfft2(x.float(), dim=axes))(x, axes=(-2, -1))
        W = w_r + 1j * w_i
        X = X * W
        y = (lambda x, s, axes=(-2,-1): torch.fft.irfft2(x, s=s, dim=axes).to(torch.bfloat16))(X, (S, D), axes=(-2, -1))
        return y

    def _B_ref(x, w1, b1, w2, b2):
        B, S, D = x.shape
        h = _layernorm(x, axis=-1)
        u = torch.einsum("bsd,sf->bdf", h, w1) + b1
        u = _gelu(u)
        y = torch.einsum("bdf,fs->bds", u, w2) + b2
        return (lambda x, *d: x.permute(*d))(y, 0, 2, 1)

    x = A_x
    xn = _layernorm(x, axis=-1)
    return x + _A_ref(xn, A_w_r, A_w_i) + _B_ref(xn, B_w1, B_b1, B_w2, B_b2)
```

```asm
; @launch grid=(256,1,1) block=(256,1,1) lds=163840
.amdgcn_target "amdgcn-amd-amdhsa--gfx950"
.text
.globl parallel_sum__spectral_gfnet__mixer_token_mlp__prompt_kernel
.p2align 8
.type parallel_sum__spectral_gfnet__mixer_token_mlp__prompt_kernel,@function
parallel_sum__spectral_gfnet__mixer_token_mlp__prompt_kernel:
s_cmp_ge_u32 s2, 256
s_cbranch_scc1 L_end_1
s_load_dwordx16 s[4:19], s[0:1], 0
s_load_dwordx4 s[20:23], s[0:1], 64
s_load_dwordx2 s[24:25], s[0:1], 80
s_getpc_b64 s[68:69]
L_cpc_5:
s_sub_u32 s68, s68, L_cpc_5-parallel_sum__spectral_gfnet__mixer_token_mlp__prompt_kernel
s_subb_u32 s69, s69, 0
s_lshr_b32 s62, s2, 3
s_mul_i32 s62, s62, 12
v_add_u32 v2, s62, v0
v_lshlrev_b32 v2, 7, v2
v_min_u32 v2, L_end_1-parallel_sum__spectral_gfnet__mixer_token_mlp__prompt_kernel-4, v2
v_cmp_gt_u32 vcc, 12, v0
s_and_saveexec_b64 s[62:63], vcc
s_cbranch_execz L_cpf_4
global_load_dword v11, v2, s[68:69]
L_cpf_4:
s_mov_b64 exec, s[62:63]
v_lshrrev_b32 v1, 6, v0
s_and_b32 s27, s2, 7
s_lshr_b32 s28, s2, 3
v_readfirstlane_b32 s3, v1
v_and_b32 v1, 63, v0
v_mov_b32 v2, 0
v_mov_b32 v3, 0
v_mov_b32 v50, 0
s_and_b32 s56, s27, 1
s_lshl_b32 s56, s56, 2
s_and_b32 s57, s28, 3
s_add_u32 s30, s56, s57
s_lshr_b32 s56, s27, 1
s_lshr_b32 s58, s28, 2
s_lshl_b32 s59, s56, 3
s_add_u32 s32, s59, s58
s_mul_i32 s59, s56, 7
s_add_u32 s31, s59, s58
s_lshl_b32 s59, s27, 2
s_add_u32 s33, s59, s57
s_mul_i32 s29, s3, 36864
s_lshl_b32 s60, s57, 3
s_mul_i32 s61, s58, 5
s_add_u32 s60, s60, s61
s_and_b32 s94, s60, 31
s_mul_i32 s60, s57, 7
s_mul_i32 s61, s58, 7
s_lshr_b32 s61, s61, 1
s_add_u32 s60, s60, s61
s_cmp_ge_u32 s60, 28
s_cselect_b32 s61, 28, 0
s_sub_u32 s95, s60, s61
s_lshl_b32 s60, s57, 1
s_add_u32 s60, s60, s58
s_and_b32 s96, s60, 7
s_waitcnt lgkmcnt(0)
s_or_b32 s56, s2, s3
s_cmp_lg_u32 s56, 0
s_cbranch_scc1 L_nn_6
s_memrealtime s[56:57]
s_waitcnt lgkmcnt(0)
s_or_b32 s56, s56, 1
v_mov_b32 v44, s56
v_mov_b32 v45, 0
s_mov_b64 exec, 1
global_store_dword v45, v44, s[22:23] sc1
s_mov_b64 exec, -1
L_nn_6:
v_lshrrev_b32 v44, 5, v1
v_lshlrev_b32 v44, 3, v44
v_bfe_u32 v45, v1, 2, 2
v_add_u32 v44, v44, v45
v_lshlrev_b32 v44, 7, v44
v_bfe_u32 v46, v1, 4, 1
v_lshlrev_b32 v46, 5, v46
v_and_b32 v47, 3, v1
v_lshl_add_u32 v46, v47, 3, v46
v_lshlrev_b32 v45, 5, v45
v_and_b32 v45, 64, v45
v_or_b32 v46, v46, v45
v_add3_u32 v44, v44, v46, s29
s_lshl_b32 s56, s3, 6
s_and_b32 s56, s56, 64
v_xor_b32 v6, s56, v44
v_xor_b32 v7, 64, v6
s_lshl_b32 s56, s3, 5
s_and_b32 s56, s56, 64
v_xor_b32 v8, s56, v44
v_xor_b32 v9, 64, v8
s_cmp_ge_u32 s28, 28
s_cselect_b32 s40, s16, s12
s_cselect_b32 s41, s17, s13
s_mov_b32 s42, 7340032
s_mov_b32 s43, 0x20000
s_cselect_b32 s57, s32, s31
s_movk_i32 s58, 3584
s_cselect_b32 s58, 4096, s58
s_lshl_b32 s57, s57, 7
s_mov_b32 s92, s57
s_lshl_b32 s70, s58, 6
v_lshrrev_b32 v44, 3, v1
v_and_b32 v45, 7, v1
v_lshlrev_b32 v46, 1, v44
v_and_b32 v46, 4, v46
v_xor_b32 v45, v45, v46
v_lshlrev_b32 v45, 4, v45
v_mad_u32_u24 v4, v44, s58, v45
v_add_u32 v4, s57, v4
s_lshl_b32 s59, s58, 3
s_sub_u32 s59, s59, 1024
v_add_u32 v5, s59, v4
s_mul_i32 s53, s3, s58
s_lshl_b32 s53, s53, 4
s_cmp_ge_u32 s28, 28
s_cselect_b32 s60, s95, s94
s_mul_i32 s60, s60, s70
s_add_u32 s53, s53, s60
s_mov_b32 s76, s40
s_mov_b32 s77, s41
s_mov_b32 s78, s42
s_mov_b32 s79, s43
s_lshl_b32 s64, s2, 2
s_add_u32 s64, s64, s3
s_lshl_b32 s65, s3, 12
s_add_u32 s65, s65, 147456
s_mov_b32 s36, s4
s_mov_b32 s37, s5
s_mov_b32 s38, 2097152
s_mov_b32 s39, 0x20000
v_lshlrev_b32 v10, 4, v1
s_lshl_b32 s61, s64, 10
s_add_u32 s62, s61, 1048576
s_mov_b32 m0, s65
s_nop 0
buffer_load_dwordx4 v10, s[36:39], s61 offen nt lds
s_add_u32 m0, s65, 1056
s_nop 0
buffer_load_dwordx4 v10, s[36:39], s62 offen nt lds
s_mov_b32 s40, s6
s_mov_b32 s41, s7
s_mov_b32 s42, 1052672
s_mov_b32 s43, 0x20000
s_mov_b32 s44, s8
s_mov_b32 s45, s9
s_mov_b32 s46, 1052672
s_mov_b32 s47, 0x20000
s_lshr_b32 s56, s3, 1
s_lshl_b32 s57, s2, 1
s_add_u32 s56, s56, s57
s_and_b32 s57, s56, 63
s_lshr_b32 s58, s56, 6
s_lshl_b32 s59, s58, 8
s_add_u32 s59, s59, s57
s_mul_i32 s59, s59, 514
s_and_b32 s60, s3, 1
s_lshl_b32 s61, s60, 8
s_add_u32 s59, s59, s61
v_lshlrev_b32 v64, 2, v1
v_add_u32 v64, s59, v64
s_mov_b32 s61, 0
buffer_load_dword v66, v64, s[40:43], s61 offen nt
buffer_load_dword v70, v64, s[44:47], s61 offen nt
s_mov_b32 s61, 32896
buffer_load_dword v67, v64, s[40:43], s61 offen nt
buffer_load_dword v71, v64, s[44:47], s61 offen nt
s_mov_b32 s61, 65792
buffer_load_dword v68, v64, s[40:43], s61 offen nt
buffer_load_dword v72, v64, s[44:47], s61 offen nt
s_mov_b32 s61, 98688
buffer_load_dword v69, v64, s[40:43], s61 offen nt
buffer_load_dword v73, v64, s[44:47], s61 offen nt
s_and_b32 s61, s56, 1
s_lshl_b32 s61, s61, 8
s_lshl_b32 s62, s58, 5
s_add_u32 s61, s61, s62
s_lshr_b32 s62, s57, 1
s_add_u32 s61, s61, s62
s_lshl_b32 s61, s61, 7
s_lshl_b32 s62, s60, 20
s_add_u32 s61, s61, s62
v_lshrrev_b32 v65, 3, v1
v_lshlrev_b32 v65, 16, v65
v_and_b32 v64, 7, v1
v_lshl_add_u32 v65, v64, 4, v65
v_add_u32 v65, s61, v65
s_cmp_lg_u32 s3, 2
s_cbranch_scc1 L_abl_7
s_lshl_b32 s56, s2, 3
v_and_b32 v96, 7, v1
v_add_u32 v96, s56, v96
v_sub_u32 v97, 0x800, v96
v_and_b32 v97, 0x7ff, v97
s_movk_i32 s56, 514
v_mul_lo_u32 v98, v96, s56
v_mul_lo_u32 v99, v97, s56
buffer_load_ushort v100, v98, s[40:43], 0 offen offset:0
buffer_load_ushort v101, v99, s[40:43], 0 offen offset:0
buffer_load_ushort v102, v98, s[40:43], 0 offen offset:512
buffer_load_ushort v103, v99, s[40:43], 0 offen offset:512
buffer_load_ushort v104, v98, s[44:47], 0 offen offset:0
buffer_load_ushort v105, v99, s[44:47], 0 offen offset:0
buffer_load_ushort v106, v98, s[44:47], 0 offen offset:512
buffer_load_ushort v107, v99, s[44:47], 0 offen offset:512
L_abl_7:
s_barrier
s_add_u32 m0, s29, 0
s_nop 0
buffer_load_dwordx4 v4, s[76:79], s53 offen  lds
buffer_load_dwordx4 v5, s[76:79], s53 offen offset:1024  lds
s_add_u32 s53, s53, s70
s_cmp_ge_u32 s53, 7340032
s_cselect_b32 s93, 7340032, 0
s_sub_u32 s53, s53, s93
s_add_u32 m0, s29, 2048
s_nop 0
buffer_load_dwordx4 v4, s[76:79], s53 offen  lds
buffer_load_dwordx4 v5, s[76:79], s53 offen offset:1024  lds
s_add_u32 s53, s53, s70
s_cmp_ge_u32 s53, 7340032
s_cselect_b32 s93, 7340032, 0
s_sub_u32 s53, s53, s93
v_and_b32 v194, 31, v1
v_cvt_f32_u32 v192, v194
v_lshrrev_b32 v194, 5, v1
v_cvt_f32_u32 v193, v194
v_mul_f32 v194, 0x3d000000, v192
v_mul_f32 v195, v192, v193
v_mul_f32 v195, 0x3e000000, v195
v_fmamk_f32 v196, v194, 0x00000000, v195
v_fmamk_f32 v197, v194, 0x3f800000, v195
v_sin_f32 v198, v196
v_sin_f32 v199, v197
v_cos_f32 v196, v196
v_cos_f32 v197, v197
v_cvt_pk_bf16_f32 v160, -v198, -v199
v_cvt_pk_bf16_f32 v152, v196, v197
v_fmamk_f32 v196, v194, 0x40000000, v195
v_fmamk_f32 v197, v194, 0x40400000, v195
v_sin_f32 v198, v196
v_sin_f32 v199, v197
v_cos_f32 v196, v196
v_cos_f32 v197, v197
v_cvt_pk_bf16_f32 v161, -v198, -v199
v_cvt_pk_bf16_f32 v153, v196, v197
v_fmamk_f32 v196, v194, 0x41000000, v195
v_fmamk_f32 v197, v194, 0x41100000, v195
v_sin_f32 v198, v196
v_sin_f32 v199, v197
v_cos_f32 v196, v196
v_cos_f32 v197, v197
v_cvt_pk_bf16_f32 v162, -v198, -v199
v_cvt_pk_bf16_f32 v154, v196, v197
v_fmamk_f32 v196, v194, 0x41200000, v195
v_fmamk_f32 v197, v194, 0x41300000, v195
v_sin_f32 v198, v196
v_sin_f32 v199, v197
v_cos_f32 v196, v196
v_cos_f32 v197, v197
v_cvt_pk_bf16_f32 v163, -v198, -v199
v_cvt_pk_bf16_f32 v155, v196, v197
v_fmamk_f32 v196, v194, 0x41800000, v195
v_fmamk_f32 v197, v194, 0x41880000, v195
v_sin_f32 v198, v196
v_sin_f32 v199, v197
v_cos_f32 v196, v196
v_cos_f32 v197, v197
v_cvt_pk_bf16_f32 v164, -v198, -v199
v_cvt_pk_bf16_f32 v156, v196, v197
v_fmamk_f32 v196, v194, 0x41900000, v195
v_fmamk_f32 v197, v194, 0x41980000, v195
v_sin_f32 v198, v196
v_sin_f32 v199, v197
v_cos_f32 v196, v196
v_cos_f32 v197, v197
v_cvt_pk_bf16_f32 v165, -v198, -v199
v_cvt_pk_bf16_f32 v157, v196, v197
v_fmamk_f32 v196, v194, 0x41c00000, v195
v_fmamk_f32 v197, v194, 0x41c80000, v195
v_sin_f32 v198, v196
v_sin_f32 v199, v197
v_cos_f32 v196, v196
v_cos_f32 v197, v197
v_cvt_pk_bf16_f32 v166, -v198, -v199
v_cvt_pk_bf16_f32 v158, v196, v197
v_fmamk_f32 v196, v194, 0x41d00000, v195
v_fmamk_f32 v197, v194, 0x41d80000, v195
v_sin_f32 v198, v196
v_sin_f32 v199, v197
v_cos_f32 v196, v196
v_cos_f32 v197, v197
v_cvt_pk_bf16_f32 v167, -v198, -v199
v_cvt_pk_bf16_f32 v159, v196, v197
v_mul_f32 v194, 0x3b000000, v192
v_mul_f32 v195, v192, v193
v_mul_f32 v195, 0x3c000000, v195
v_fmamk_f32 v168, v194, 0x00000000, v195
v_sin_f32 v176, v168
v_cos_f32 v168, v168
v_fmamk_f32 v169, v194, 0x3f800000, v195
v_sin_f32 v177, v169
v_cos_f32 v169, v169
v_fmamk_f32 v170, v194, 0x40000000, v195
v_sin_f32 v178, v170
v_cos_f32 v170, v170
v_fmamk_f32 v171, v194, 0x40400000, v195
v_sin_f32 v179, v171
v_cos_f32 v171, v171
v_fmamk_f32 v172, v194, 0x41000000, v195
v_sin_f32 v180, v172
v_cos_f32 v172, v172
v_fmamk_f32 v173, v194, 0x41100000, v195
v_sin_f32 v181, v173
v_cos_f32 v173, v173
v_fmamk_f32 v174, v194, 0x41200000, v195
v_sin_f32 v182, v174
v_cos_f32 v174, v174
v_fmamk_f32 v175, v194, 0x41300000, v195
v_sin_f32 v183, v175
v_cos_f32 v175, v175
v_bfe_u32 v194, v1, 3, 2
v_lshlrev_b32 v194, 2, v194
v_bfe_u32 v195, v1, 2, 1
v_lshl_add_u32 v194, v195, 1, v194
v_bfe_u32 v195, v1, 1, 1
v_add_u32 v194, v194, v195
v_cvt_f32_u32 v194, v194
v_and_b32 v195, 1, v1
v_cvt_f32_u32 v195, v195
v_mul_f32 v195, 0x3e800000, v195
v_mul_f32 v196, 0x3d800000, v194
v_mul_f32 v197, v194, v193
v_fmamk_f32 v197, v197, 0x3e800000, v195
v_fmamk_f32 v198, v196, 0x00000000, v197
v_fmamk_f32 v199, v196, 0x3f800000, v197
v_sin_f32 v200, v198
v_sin_f32 v201, v199
v_cos_f32 v198, v198
v_cos_f32 v199, v199
v_cvt_pk_bf16_f32 v188, v200, v201
v_cvt_pk_bf16_f32 v184, v198, v199
v_fmamk_f32 v198, v196, 0x40000000, v197
v_fmamk_f32 v199, v196, 0x40400000, v197
v_sin_f32 v200, v198
v_sin_f32 v201, v199
v_cos_f32 v198, v198
v_cos_f32 v199, v199
v_cvt_pk_bf16_f32 v189, v200, v201
v_cvt_pk_bf16_f32 v185, v198, v199
v_fmamk_f32 v198, v196, 0x41000000, v197
v_fmamk_f32 v199, v196, 0x41100000, v197
v_sin_f32 v200, v198
v_sin_f32 v201, v199
v_cos_f32 v198, v198
v_cos_f32 v199, v199
v_cvt_pk_bf16_f32 v190, v200, v201
v_cvt_pk_bf16_f32 v186, v198, v199
v_fmamk_f32 v198, v196, 0x41200000, v197
v_fmamk_f32 v199, v196, 0x41300000, v197
v_sin_f32 v200, v198
v_sin_f32 v201, v199
v_cos_f32 v198, v198
v_cos_f32 v199, v199
v_cvt_pk_bf16_f32 v191, v200, v201
v_cvt_pk_bf16_f32 v187, v198, v199
v_cvt_f32_u32 v248, s64
v_mul_f32 v248, 0x3a000000, v248
v_sin_f32 v249, v248
v_cos_f32 v248, v248
v_mov_b32 v246, 0x3b000000
v_lshlrev_b32 v44, 4, v1
v_add_u32 v44, s65, v44
v_bfe_u32 v10, v1, 4, 1
v_mul_u32_u24 v10, 1056, v10
v_and_b32 v241, 15, v1
v_lshl_add_u32 v10, v241, 1, v10
v_lshrrev_b32 v241, 5, v1
v_lshl_add_u32 v10, v241, 7, v10
v_add_u32 v10, s65, v10
v_mov_b32 v128, 0
v_mov_b32 v129, 0
v_mov_b32 v130, 0
v_mov_b32 v131, 0
v_mov_b32 v132, 0
v_mov_b32 v133, 0
v_mov_b32 v134, 0
v_mov_b32 v135, 0
v_mov_b32 v136, 0
v_mov_b32 v137, 0
v_mov_b32 v138, 0
v_mov_b32 v139, 0
v_mov_b32 v140, 0
v_mov_b32 v141, 0
v_mov_b32 v142, 0
v_mov_b32 v143, 0
s_waitcnt vmcnt(12)
ds_read_u16_d16_hi v128, v10 offset:0
ds_read_u16_d16_hi v129, v10 offset:32
ds_read_u16_d16_hi v130, v10 offset:64
ds_read_u16_d16_hi v131, v10 offset:96
ds_read_u16_d16_hi v132, v10 offset:256
ds_read_u16_d16_hi v133, v10 offset:288
ds_read_u16_d16_hi v134, v10 offset:320
ds_read_u16_d16_hi v135, v10 offset:352
ds_read_u16_d16_hi v136, v10 offset:512
ds_read_u16_d16_hi v137, v10 offset:544
ds_read_u16_d16_hi v138, v10 offset:576
ds_read_u16_d16_hi v139, v10 offset:608
ds_read_u16_d16_hi v140, v10 offset:768
ds_read_u16_d16_hi v141, v10 offset:800
ds_read_u16_d16_hi v142, v10 offset:832
ds_read_u16_d16_hi v143, v10 offset:864
s_waitcnt lgkmcnt(0)
s_add_u32 m0, s29, 4096
s_nop 0
buffer_load_dwordx4 v4, s[76:79], s53 offen  lds
buffer_load_dwordx4 v5, s[76:79], s53 offen offset:1024  lds
s_add_u32 s53, s53, s70
s_cmp_ge_u32 s53, 7340032
s_cselect_b32 s93, 7340032, 0
s_sub_u32 s53, s53, s93
s_add_u32 m0, s29, 6144
s_nop 0
buffer_load_dwordx4 v4, s[76:79], s53 offen  lds
buffer_load_dwordx4 v5, s[76:79], s53 offen offset:1024  lds
s_add_u32 s53, s53, s70
s_cmp_ge_u32 s53, 7340032
s_cselect_b32 s93, 7340032, 0
s_sub_u32 s53, s53, s93
s_add_u32 m0, s29, 8192
s_nop 0
buffer_load_dwordx4 v4, s[76:79], s53 offen  lds
buffer_load_dwordx4 v5, s[76:79], s53 offen offset:1024  lds
s_add_u32 s53, s53, s70
s_cmp_ge_u32 s53, 7340032
s_cselect_b32 s93, 7340032, 0
s_sub_u32 s53, s53, s93
v_pk_add_f32 v[240:241], v[128:129], v[130:131]
v_pk_add_f32 v[242:243], v[132:133], v[134:135]
v_pk_add_f32 v[240:241], v[240:241], v[136:137]
v_pk_add_f32 v[242:243], v[242:243], v[138:139]
v_pk_add_f32 v[240:241], v[240:241], v[140:141]
v_pk_add_f32 v[242:243], v[242:243], v[142:143]
v_pk_add_f32 v[240:241], v[240:241], v[242:243]
v_add_f32 v240, v240, v241
s_nop 1
v_add_f32_dpp v240, v240, v240 row_ror:8 row_mask:0xf bank_mask:0xf
s_nop 1
v_add_f32_dpp v240, v240, v240 row_ror:4 row_mask:0xf bank_mask:0xf
s_nop 1
v_add_f32_dpp v240, v240, v240 row_ror:2 row_mask:0xf bank_mask:0xf
s_nop 1
v_add_f32_dpp v240, v240, v240 row_ror:1 row_mask:0xf bank_mask:0xf
v_mov_b32 v241, v240
s_nop 1
v_permlane32_swap_b32 v240, v241
s_nop 0
v_add_f32 v240, v240, v241
v_mul_f32 v240, 0x3b000000, v240
v_cvt_pk_bf16_f32 v242, v240, v240
v_lshlrev_b32 v242, 16, v242
v_sub_f32 v243, v240, v242
v_pk_add_f32 v[128:129], v[128:129], v[242:243] op_sel_hi:[1,0] neg_lo:[0,1] neg_hi:[0,1]
v_pk_add_f32 v[130:131], v[130:131], v[242:243] op_sel_hi:[1,0] neg_lo:[0,1] neg_hi:[0,1]
v_pk_add_f32 v[132:133], v[132:133], v[242:243] op_sel_hi:[1,0] neg_lo:[0,1] neg_hi:[0,1]
v_pk_add_f32 v[134:135], v[134:135], v[242:243] op_sel_hi:[1,0] neg_lo:[0,1] neg_hi:[0,1]
v_pk_add_f32 v[136:137], v[136:137], v[242:243] op_sel_hi:[1,0] neg_lo:[0,1] neg_hi:[0,1]
v_pk_add_f32 v[138:139], v[138:139], v[242:243] op_sel_hi:[1,0] neg_lo:[0,1] neg_hi:[0,1]
v_pk_add_f32 v[140:141], v[140:141], v[242:243] op_sel_hi:[1,0] neg_lo:[0,1] neg_hi:[0,1]
v_pk_add_f32 v[142:143], v[142:143], v[242:243] op_sel_hi:[1,0] neg_lo:[0,1] neg_hi:[0,1]
v_mul_f32 v243, v243, v243
v_pk_mul_f32 v[240:241], v[128:129], v[128:129]
v_pk_mul_f32 v[244:245], v[130:131], v[130:131]
v_pk_fma_f32 v[240:241], v[132:133], v[132:133], v[240:241]
v_pk_fma_f32 v[244:245], v[134:135], v[134:135], v[244:245]
v_pk_fma_f32 v[240:241], v[136:137], v[136:137], v[240:241]
v_pk_fma_f32 v[244:245], v[138:139], v[138:139], v[244:245]
v_pk_fma_f32 v[240:241], v[140:141], v[140:141], v[240:241]
v_pk_fma_f32 v[244:245], v[142:143], v[142:143], v[244:245]
v_pk_add_f32 v[240:241], v[240:241], v[244:245]
v_add_f32 v240, v240, v241
v_cvt_pk_bf16_f32 v144, v128, v129
v_cvt_pk_bf16_f32 v145, v130, v131
v_add_f32_dpp v240, v240, v240 row_ror:8 row_mask:0xf bank_mask:0xf
v_cvt_pk_bf16_f32 v146, v132, v133
v_cvt_pk_bf16_f32 v147, v134, v135
v_add_f32_dpp v240, v240, v240 row_ror:4 row_mask:0xf bank_mask:0xf
v_cvt_pk_bf16_f32 v148, v136, v137
v_cvt_pk_bf16_f32 v149, v138, v139
v_add_f32_dpp v240, v240, v240 row_ror:2 row_mask:0xf bank_mask:0xf
v_cvt_pk_bf16_f32 v150, v140, v141
v_cvt_pk_bf16_f32 v151, v142, v143
v_add_f32_dpp v240, v240, v240 row_ror:1 row_mask:0xf bank_mask:0xf
v_lshlrev_b32 v128, 16, v144
v_mov_b32 v241, v240
v_and_b32 v129, 0xffff0000, v144
v_lshlrev_b32 v130, 16, v145
v_permlane32_swap_b32 v240, v241
v_and_b32 v131, 0xffff0000, v145
v_add_f32 v240, v240, v241
v_fma_f32 v240, v240, v246, -v243
v_max_f32 v240, 0, v240
v_cvt_pk_bf16_f32 v240, v240, v240
v_lshlrev_b32 v240, 16, v240
v_add_f32 v240, 0x3727c5ac, v240
v_cvt_pk_bf16_f32 v240, v240, v240
v_lshlrev_b32 v240, 16, v240
v_sqrt_f32 v240, v240
v_lshlrev_b32 v132, 16, v146
v_cvt_pk_bf16_f32 v240, v240, v240
v_lshlrev_b32 v240, 16, v240
v_rcp_f32 v240, v240
v_and_b32 v133, 0xffff0000, v146
v_lshlrev_b32 v134, 16, v147
v_and_b32 v135, 0xffff0000, v147
v_lshlrev_b32 v136, 16, v148
v_and_b32 v137, 0xffff0000, v148
v_lshlrev_b32 v138, 16, v149
v_and_b32 v139, 0xffff0000, v149
v_lshlrev_b32 v140, 16, v150
v_and_b32 v141, 0xffff0000, v150
v_lshlrev_b32 v142, 16, v151
v_and_b32 v143, 0xffff0000, v151
v_pk_mul_f32 v[128:129], v[128:129], v[240:241] op_sel_hi:[1,0]
v_pk_mul_f32 v[130:131], v[130:131], v[240:241] op_sel_hi:[1,0]
v_pk_mul_f32 v[132:133], v[132:133], v[240:241] op_sel_hi:[1,0]
v_pk_mul_f32 v[134:135], v[134:135], v[240:241] op_sel_hi:[1,0]
v_pk_mul_f32 v[136:137], v[136:137], v[240:241] op_sel_hi:[1,0]
v_pk_mul_f32 v[138:139], v[138:139], v[240:241] op_sel_hi:[1,0]
v_pk_mul_f32 v[140:141], v[140:141], v[240:241] op_sel_hi:[1,0]
v_pk_mul_f32 v[142:143], v[142:143], v[240:241] op_sel_hi:[1,0]
v_cvt_pk_bf16_f32 v144, v128, v129
v_cvt_pk_bf16_f32 v145, v130, v131
v_cvt_pk_bf16_f32 v146, v132, v133
v_cvt_pk_bf16_f32 v147, v134, v135
v_cvt_pk_bf16_f32 v148, v136, v137
v_cvt_pk_bf16_f32 v149, v138, v139
v_cvt_pk_bf16_f32 v150, v140, v141
v_cvt_pk_bf16_f32 v151, v142, v143
v_lshlrev_b32 v128, 16, v144
v_and_b32 v129, 0xffff0000, v144
v_lshlrev_b32 v130, 16, v145
v_and_b32 v131, 0xffff0000, v145
v_lshlrev_b32 v132, 16, v146
v_and_b32 v133, 0xffff0000, v146
v_lshlrev_b32 v134, 16, v147
v_and_b32 v135, 0xffff0000, v147
v_lshlrev_b32 v136, 16, v148
v_and_b32 v137, 0xffff0000, v148
v_lshlrev_b32 v138, 16, v149
v_and_b32 v139, 0xffff0000, v149
v_lshlrev_b32 v140, 16, v150
v_and_b32 v141, 0xffff0000, v150
v_lshlrev_b32 v142, 16, v151
v_and_b32 v143, 0xffff0000, v151
v_mfma_f32_32x32x16_bf16 v[192:207], v[144:147], v[152:155], 0
v_mfma_f32_32x32x16_bf16 v[208:223], v[144:147], v[160:163], 0
v_mfma_f32_32x32x16_bf16 v[192:207], v[148:151], v[156:159], v[192:207]
v_mfma_f32_32x32x16_bf16 v[208:223], v[148:151], v[164:167], v[208:223]
s_waitcnt vmcnt(10)
s_mov_b32 s66, 0x05040100
s_mov_b32 s67, 0x07060302
v_perm_b32 v74, v70, v66, s66
v_perm_b32 v75, v71, v67, s66
v_perm_b32 v76, v72, v68, s66
v_perm_b32 v77, v73, v69, s66
v_perm_b32 v78, v70, v66, s67
v_perm_b32 v79, v71, v67, s67
v_perm_b32 v80, v72, v68, s67
v_perm_b32 v81, v73, v69, s67
v_lshlrev_b32 v44, 5, v1
v_add_u32 v44, s29, v44
ds_write_b128 v44, v[74:77] offset:34816
ds_write_b128 v44, v[78:81] offset:34832
v_lshlrev_b32 v44, 4, v1
v_add_u32 v44, s29, v44
ds_read_b128 v[84:87], v44 offset:34816
ds_read_b128 v[88:91], v44 offset:35840
s_cmp_lg_u32 s3, 2
s_cbranch_scc1 L_abf_8
v_lshlrev_b32 v100, 16, v100
v_lshlrev_b32 v101, 16, v101
v_lshlrev_b32 v102, 16, v102
v_lshlrev_b32 v103, 16, v103
v_lshlrev_b32 v104, 16, v104
v_lshlrev_b32 v105, 16, v105
v_lshlrev_b32 v106, 16, v106
v_lshlrev_b32 v107, 16, v107
v_add_f32 v98, v100, v101
v_add_f32 v99, v102, v103
v_sub_f32 v100, v104, v105
v_sub_f32 v101, v106, v107
v_mul_f32 v98, 0.5, v98
v_mul_f32 v100, 0.5, v100
v_add_f32 v102, v98, v99
v_add_f32 v103, v100, v101
v_sub_f32 v104, v98, v99
v_sub_f32 v105, v100, v101
v_mul_f32 v102, 0x3e800000, v102
v_mul_f32 v103, 0x3e800000, v103
v_mul_f32 v104, 0x3e800000, v104
v_mul_f32 v105, 0x3e800000, v105
v_cvt_pk_bf16_f32 v98, v102, v103
v_cvt_pk_bf16_f32 v99, v104, v105
v_and_b32 v100, 1, v96
v_lshlrev_b32 v100, 8, v100
v_lshrrev_b32 v101, 8, v96
v_lshl_add_u32 v100, v101, 5, v100
v_bfe_u32 v101, v96, 1, 5
v_add_u32 v100, v100, v101
v_bfe_u32 v101, v96, 6, 2
v_lshlrev_b32 v101, 2, v101
v_lshl_add_u32 v100, v100, 4, v101
s_add_u32 s48, s24, 8912896
s_addc_u32 s49, s25, 0
s_mov_b32 s50, 16384
s_mov_b32 s51, 0x20000
s_mov_b64 exec, 0xff
buffer_store_dword v98, v100, s[48:51], 0 offen sc1
v_add_u32 v100, 8192, v100
buffer_store_dword v99, v100, s[48:51], 0 offen sc1
s_mov_b64 exec, -1
L_abf_8:
s_add_u32 s48, s24, 6815744
s_addc_u32 s49, s25, 0
s_mov_b32 s50, 2097152
s_mov_b32 s51, 0x20000
s_mov_b32 s61, 524288
s_waitcnt lgkmcnt(0)
buffer_store_dwordx4 v[84:87], v65, s[48:51], 0 offen sc1
buffer_store_dwordx4 v[88:91], v65, s[48:51], s61 offen sc1
v_lshlrev_b32 v44, 4, v1
v_add_u32 v44, s65, v44
v_pk_add_f32 v[240:241], v[128:129], v[130:131]
v_pk_add_f32 v[242:243], v[132:133], v[134:135]
v_pk_add_f32 v[240:241], v[240:241], v[136:137]
v_pk_add_f32 v[242:243], v[242:243], v[138:139]
v_pk_add_f32 v[240:241], v[240:241], v[140:141]
v_pk_add_f32 v[242:243], v[242:243], v[142:143]
v_pk_add_f32 v[240:241], v[240:241], v[242:243]
v_add_f32 v240, v240, v241
s_nop 1
v_add_f32_dpp v240, v240, v240 row_ror:8 row_mask:0xf bank_mask:0xf
s_nop 1
v_add_f32_dpp v240, v240, v240 row_ror:4 row_mask:0xf bank_mask:0xf
s_nop 1
v_add_f32_dpp v240, v240, v240 row_ror:2 row_mask:0xf bank_mask:0xf
s_nop 1
v_add_f32_dpp v240, v240, v240 row_ror:1 row_mask:0xf bank_mask:0xf
v_mov_b32 v241, v240
s_nop 1
v_permlane32_swap_b32 v240, v241
s_nop 0
v_add_f32 v240, v240, v241
v_mul_f32 v240, 0x3b000000, v240
v_cvt_pk_bf16_f32 v242, v240, v240
v_lshlrev_b32 v242, 16, v242
v_sub_f32 v243, v240, v242
v_pk_add_f32 v[128:129], v[128:129], v[242:243] op_sel_hi:[1,0] neg_lo:[0,1] neg_hi:[0,1]
v_pk_add_f32 v[130:131], v[130:131], v[242:243] op_sel_hi:[1,0] neg_lo:[0,1] neg_hi:[0,1]
v_pk_add_f32 v[132:133], v[132:133], v[242:243] op_sel_hi:[1,0] neg_lo:[0,1] neg_hi:[0,1]
v_pk_add_f32 v[134:135], v[134:135], v[242:243] op_sel_hi:[1,0] neg_lo:[0,1] neg_hi:[0,1]
v_pk_add_f32 v[136:137], v[136:137], v[242:243] op_sel_hi:[1,0] neg_lo:[0,1] neg_hi:[0,1]
v_pk_add_f32 v[138:139], v[138:139], v[242:243] op_sel_hi:[1,0] neg_lo:[0,1] neg_hi:[0,1]
v_pk_add_f32 v[140:141], v[140:141], v[242:243] op_sel_hi:[1,0] neg_lo:[0,1] neg_hi:[0,1]
v_pk_add_f32 v[142:143], v[142:143], v[242:243] op_sel_hi:[1,0] neg_lo:[0,1] neg_hi:[0,1]
v_mul_f32 v243, v243, v243
v_pk_mul_f32 v[240:241], v[128:129], v[128:129]
v_pk_mul_f32 v[244:245], v[130:131], v[130:131]
v_pk_fma_f32 v[240:241], v[132:133], v[132:133], v[240:241]
v_pk_fma_f32 v[244:245], v[134:135], v[134:135], v[244:245]
v_pk_fma_f32 v[240:241], v[136:137], v[136:137], v[240:241]
v_pk_fma_f32 v[244:245], v[138:139], v[138:139], v[244:245]
v_pk_fma_f32 v[240:241], v[140:141], v[140:141], v[240:241]
v_pk_fma_f32 v[244:245], v[142:143], v[142:143], v[244:245]
v_pk_add_f32 v[240:241], v[240:241], v[244:245]
v_add_f32 v240, v240, v241
v_cvt_pk_bf16_f32 v144, v128, v129
v_cvt_pk_bf16_f32 v145, v130, v131
v_add_f32_dpp v240, v240, v240 row_ror:8 row_mask:0xf bank_mask:0xf
v_cvt_pk_bf16_f32 v146, v132, v133
v_cvt_pk_bf16_f32 v147, v134, v135
v_add_f32_dpp v240, v240, v240 row_ror:4 row_mask:0xf bank_mask:0xf
v_cvt_pk_bf16_f32 v148, v136, v137
v_cvt_pk_bf16_f32 v149, v138, v139
v_add_f32_dpp v240, v240, v240 row_ror:2 row_mask:0xf bank_mask:0xf
v_cvt_pk_bf16_f32 v150, v140, v141
v_cvt_pk_bf16_f32 v151, v142, v143
v_add_f32_dpp v240, v240, v240 row_ror:1 row_mask:0xf bank_mask:0xf
v_lshlrev_b32 v128, 16, v144
v_mov_b32 v241, v240
v_and_b32 v129, 0xffff0000, v144
v_lshlrev_b32 v130, 16, v145
v_permlane32_swap_b32 v240, v241
v_and_b32 v131, 0xffff0000, v145
v_add_f32 v240, v240, v241
v_fma_f32 v240, v240, v246, -v243
v_max_f32 v240, 0, v240
v_cvt_pk_bf16_f32 v240, v240, v240
v_lshlrev_b32 v240, 16, v240
v_add_f32 v240, 0x3727c5ac, v240
v_cvt_pk_bf16_f32 v240, v240, v240
v_lshlrev_b32 v240, 16, v240
v_sqrt_f32 v240, v240
v_lshlrev_b32 v132, 16, v146
v_cvt_pk_bf16_f32 v240, v240, v240
v_lshlrev_b32 v240, 16, v240
v_rcp_f32 v240, v240
v_and_b32 v133, 0xffff0000, v146
v_lshlrev_b32 v134, 16, v147
v_and_b32 v135, 0xffff0000, v147
v_lshlrev_b32 v136, 16, v148
v_and_b32 v137, 0xffff0000, v148
v_lshlrev_b32 v138, 16, v149
v_and_b32 v139, 0xffff0000, v149
v_lshlrev_b32 v140, 16, v150
v_and_b32 v141, 0xffff0000, v150
v_lshlrev_b32 v142, 16, v151
v_and_b32 v143, 0xffff0000, v151
v_pk_mul_f32 v[128:129], v[128:129], v[240:241] op_sel_hi:[1,0]
v_pk_mul_f32 v[130:131], v[130:131], v[240:241] op_sel_hi:[1,0]
v_pk_mul_f32 v[132:133], v[132:133], v[240:241] op_sel_hi:[1,0]
v_pk_mul_f32 v[134:135], v[134:135], v[240:241] op_sel_hi:[1,0]
v_pk_mul_f32 v[136:137], v[136:137], v[240:241] op_sel_hi:[1,0]
v_pk_mul_f32 v[138:139], v[138:139], v[240:241] op_sel_hi:[1,0]
v_pk_mul_f32 v[140:141], v[140:141], v[240:241] op_sel_hi:[1,0]
v_pk_mul_f32 v[142:143], v[142:143], v[240:241] op_sel_hi:[1,0]
v_cvt_pk_bf16_f32 v144, v128, v129
v_cvt_pk_bf16_f32 v145, v130, v131
v_cvt_pk_bf16_f32 v146, v132, v133
v_cvt_pk_bf16_f32 v147, v134, v135
v_cvt_pk_bf16_f32 v148, v136, v137
v_cvt_pk_bf16_f32 v149, v138, v139
v_cvt_pk_bf16_f32 v150, v140, v141
v_cvt_pk_bf16_f32 v151, v142, v143
ds_write_b16 v10, v144 offset:0
ds_write_b16_d16_hi v10, v144 offset:32
ds_write_b16 v10, v145 offset:64
ds_write_b16_d16_hi v10, v145 offset:96
ds_write_b16 v10, v146 offset:256
ds_write_b16_d16_hi v10, v146 offset:288
ds_write_b16 v10, v147 offset:320
ds_write_b16_d16_hi v10, v147 offset:352
ds_write_b16 v10, v148 offset:512
ds_write_b16_d16_hi v10, v148 offset:544
ds_write_b16 v10, v149 offset:576
ds_write_b16_d16_hi v10, v149 offset:608
ds_write_b16 v10, v150 offset:768
ds_write_b16_d16_hi v10, v150 offset:800
ds_write_b16 v10, v151 offset:832
ds_write_b16_d16_hi v10, v151 offset:864
ds_read_b128 v[84:87], v44
ds_read_b128 v[88:91], v44 offset:1056
s_mov_b32 s48, s24
s_mov_b32 s49, s25
s_mov_b32 s50, 2097152
s_mov_b32 s51, 0x20000
s_lshl_b32 s61, s64, 10
s_add_u32 s62, s61, 1048576
v_lshlrev_b32 v241, 4, v1
v_pk_mul_f32 v[128:129], v[192:193], v[168:169]
v_pk_mul_f32 v[132:133], v[208:209], v[168:169]
v_pk_fma_f32 v[128:129], v[208:209], v[176:177], v[128:129]
v_pk_fma_f32 v[132:133], v[192:193], v[176:177], v[132:133] neg_lo:[1,0,0] neg_hi:[1,0,0]
v_pk_mul_f32 v[130:131], v[194:195], v[170:171]
v_pk_mul_f32 v[134:135], v[210:211], v[170:171]
v_pk_fma_f32 v[130:131], v[210:211], v[178:179], v[130:131]
v_pk_fma_f32 v[134:135], v[194:195], v[178:179], v[134:135] neg_lo:[1,0,0] neg_hi:[1,0,0]
v_cvt_pk_bf16_f32 v224, v128, v129
v_cvt_pk_bf16_f32 v225, v130, v131
v_cvt_pk_bf16_f32 v232, v132, v133
v_cvt_pk_bf16_f32 v233, v134, v135
s_waitcnt lgkmcnt(0)
buffer_store_dwordx4 v[84:87], v241, s[48:51], s61 offen sc1
buffer_store_dwordx4 v[88:91], v241, s[48:51], s62 offen sc1
v_pk_mul_f32 v[128:129], v[196:197], v[172:173]
v_pk_mul_f32 v[132:133], v[212:213], v[172:173]
v_pk_fma_f32 v[128:129], v[212:213], v[180:181], v[128:129]
v_pk_fma_f32 v[132:133], v[196:197], v[180:181], v[132:133] neg_lo:[1,0,0] neg_hi:[1,0,0]
v_pk_mul_f32 v[130:131], v[198:199], v[174:175]
v_pk_mul_f32 v[134:135], v[214:215], v[174:175]
v_pk_fma_f32 v[130:131], v[214:215], v[182:183], v[130:131]
v_pk_fma_f32 v[134:135], v[198:199], v[182:183], v[134:135] neg_lo:[1,0,0] neg_hi:[1,0,0]
v_cvt_pk_bf16_f32 v226, v128, v129
v_cvt_pk_bf16_f32 v227, v130, v131
v_cvt_pk_bf16_f32 v234, v132, v133
v_cvt_pk_bf16_f32 v235, v134, v135
v_pk_mul_f32 v[128:129], v[200:201], v[168:169]
v_pk_mul_f32 v[132:133], v[216:217], v[168:169]
v_pk_fma_f32 v[128:129], v[216:217], v[176:177], v[128:129]
v_pk_fma_f32 v[132:133], v[200:201], v[176:177], v[132:133] neg_lo:[1,0,0] neg_hi:[1,0,0]
v_pk_mul_f32 v[130:131], v[202:203], v[170:171]
v_pk_mul_f32 v[134:135], v[218:219], v[170:171]
v_pk_fma_f32 v[130:131], v[218:219], v[178:179], v[130:131]
v_pk_fma_f32 v[134:135], v[202:203], v[178:179], v[134:135] neg_lo:[1,0,0] neg_hi:[1,0,0]
v_cvt_pk_bf16_f32 v228, v128, v129
v_cvt_pk_bf16_f32 v229, v130, v131
v_cvt_pk_bf16_f32 v236, v132, v133
v_cvt_pk_bf16_f32 v237, v134, v135
v_pk_mul_f32 v[128:129], v[204:205], v[172:173]
v_pk_mul_f32 v[132:133], v[220:221], v[172:173]
v_pk_fma_f32 v[128:129], v[220:221], v[180:181], v[128:129]
v_pk_fma_f32 v[132:133], v[204:205], v[180:181], v[132:133] neg_lo:[1,0,0] neg_hi:[1,0,0]
v_pk_mul_f32 v[130:131], v[206:207], v[174:175]
v_pk_mul_f32 v[134:135], v[222:223], v[174:175]
v_pk_fma_f32 v[130:131], v[222:223], v[182:183], v[130:131]
v_pk_fma_f32 v[134:135], v[206:207], v[182:183], v[134:135] neg_lo:[1,0,0] neg_hi:[1,0,0]
v_cvt_pk_bf16_f32 v230, v128, v129
v_cvt_pk_bf16_f32 v231, v130, v131
v_cvt_pk_bf16_f32 v238, v132, v133
v_cvt_pk_bf16_f32 v239, v134, v135
s_nop 1
v_mfma_f32_32x32x16_bf16 v[192:207], v[184:187], v[224:227], 0
v_mfma_f32_32x32x16_bf16 v[208:223], v[184:187], v[228:231], 0
v_mfma_f32_32x32x16_bf16 v[192:207], v[188:191], v[232:235], v[192:207]
v_mfma_f32_32x32x16_bf16 v[208:223], v[188:191], v[236:239], v[208:223]
v_and_b32 v240, 31, v0
v_lshrrev_b32 v241, 5, v0
v_lshrrev_b32 v242, 2, v241
v_lshlrev_b32 v242, 10, v242
v_bfe_u32 v243, v241, 1, 1
v_lshl_add_u32 v240, v243, 5, v240
v_lshl_add_u32 v240, v240, 4, v242
v_and_b32 v241, 1, v241
v_lshl_add_u32 v240, v241, 3, v240
v_add_u32 v240, 147456, v240
v_lshrrev_b32 v241, 3, v0
v_lshlrev_b32 v241, 15, v241
v_and_b32 v242, 7, v0
v_lshl_add_u32 v241, v242, 4, v241
s_lshl_b32 s61, s2, 7
v_add_u32 v241, s61, v241
s_nop 3
s_mov_b64 exec, 1
v_mov_b32 v193, v200
v_mov_b32 v209, v216
s_mov_b64 exec, -1
v_pk_add_f32 v[128:129], v[192:193], v[208:209]
v_pk_add_f32 v[136:137], v[192:193], v[208:209] neg_lo:[0,1] neg_hi:[0,1]
v_pk_add_f32 v[130:131], v[194:195], v[210:211]
v_pk_add_f32 v[138:139], v[194:195], v[210:211] neg_lo:[0,1] neg_hi:[0,1]
v_pk_add_f32 v[132:133], v[196:197], v[212:213]
v_pk_add_f32 v[140:141], v[196:197], v[212:213] neg_lo:[0,1] neg_hi:[0,1]
v_pk_add_f32 v[134:135], v[198:199], v[214:215]
v_pk_add_f32 v[142:143], v[198:199], v[214:215] neg_lo:[0,1] neg_hi:[0,1]
v_mul_f32 v144, v136, v248
v_mul_f32 v145, v137, v248
v_fmac_f32 v144, v137, v249
v_fma_f32 v145, -v136, v249, v145
v_mul_f32 v146, v138, v248
v_mul_f32 v147, v139, v248
v_fmac_f32 v146, v139, v249
v_fma_f32 v147, -v138, v249, v147
v_mul_f32 v148, v140, v248
v_mul_f32 v149, v141, v248
v_fmac_f32 v148, v141, v249
v_fma_f32 v149, -v140, v249, v149
v_mul_f32 v150, v142, v248
v_mul_f32 v151, v143, v248
v_fmac_f32 v150, v143, v249
v_fma_f32 v151, -v142, v249, v151
ds_write_b128 v44, v[128:131] offset:0
ds_write_b128 v44, v[144:147] offset:2048
ds_write_b128 v44, v[132:135] offset:1024
ds_write_b128 v44, v[148:151] offset:3072
s_add_u32 s48, s24, 4718592
s_addc_u32 s49, s25, 0
s_mov_b32 s50, 2097152
s_mov_b32 s51, 0x20000
s_waitcnt lgkmcnt(0)
s_barrier
ds_read_b64 v[152:153], v240 offset:0
ds_read_b64 v[154:155], v240 offset:4096
ds_read_b64 v[156:157], v240 offset:8192
ds_read_b64 v[158:159], v240 offset:12288
ds_read_b64 v[168:169], v240 offset:2048
ds_read_b64 v[170:171], v240 offset:6144
ds_read_b64 v[172:173], v240 offset:10240
ds_read_b64 v[174:175], v240 offset:14336
s_mov_b32 s61, 1048576
s_waitcnt lgkmcnt(4)
v_cvt_pk_bf16_f32 v160, v152, v154
v_cvt_pk_bf16_f32 v161, v156, v158
v_cvt_pk_bf16_f32 v162, v153, v155
v_cvt_pk_bf16_f32 v163, v157, v159
buffer_store_dwordx4 v[160:163], v241, s[48:51], 0 offen sc1
s_waitcnt lgkmcnt(0)
v_cvt_pk_bf16_f32 v176, v168, v170
v_cvt_pk_bf16_f32 v177, v172, v174
v_cvt_pk_bf16_f32 v178, v169, v171
v_cvt_pk_bf16_f32 v179, v173, v175
buffer_store_dwordx4 v[176:179], v241, s[48:51], s61 offen sc1
v_mov_b32 v242, 0
global_load_dword v243, v242, s[22:23] sc1
s_add_u32 m0, s29, 10240
s_nop 0
buffer_load_dwordx4 v4, s[76:79], s53 offen  lds
buffer_load_dwordx4 v5, s[76:79], s53 offen offset:1024  lds
s_add_u32 s53, s53, s70
s_cmp_ge_u32 s53, 7340032
s_cselect_b32 s93, 7340032, 0
s_sub_u32 s53, s53, s93
s_add_u32 m0, s29, 12288
s_nop 0
buffer_load_dwordx4 v4, s[76:79], s53 offen  lds
buffer_load_dwordx4 v5, s[76:79], s53 offen offset:1024  lds
s_add_u32 s53, s53, s70
s_cmp_ge_u32 s53, 7340032
s_cselect_b32 s93, 7340032, 0
s_sub_u32 s53, s53, s93
s_add_u32 m0, s29, 14336
s_nop 0
buffer_load_dwordx4 v4, s[76:79], s53 offen  lds
buffer_load_dwordx4 v5, s[76:79], s53 offen offset:1024  lds
s_add_u32 s53, s53, s70
s_cmp_ge_u32 s53, 7340032
s_cselect_b32 s93, 7340032, 0
s_sub_u32 s53, s53, s93
s_add_u32 m0, s29, 16384
s_nop 0
buffer_load_dwordx4 v4, s[76:79], s53 offen  lds
buffer_load_dwordx4 v5, s[76:79], s53 offen offset:1024  lds
s_add_u32 s53, s53, s70
s_cmp_ge_u32 s53, 7340032
s_cselect_b32 s93, 7340032, 0
s_sub_u32 s53, s53, s93
s_add_u32 m0, s29, 18432
s_nop 0
buffer_load_dwordx4 v4, s[76:79], s53 offen  lds
buffer_load_dwordx4 v5, s[76:79], s53 offen offset:1024  lds
s_add_u32 s53, s53, s70
s_cmp_ge_u32 s53, 7340032
s_cselect_b32 s93, 7340032, 0
s_sub_u32 s53, s53, s93
s_add_u32 m0, s29, 20480
s_nop 0
buffer_load_dwordx4 v4, s[76:79], s53 offen  lds
buffer_load_dwordx4 v5, s[76:79], s53 offen offset:1024  lds
s_add_u32 s53, s53, s70
s_cmp_ge_u32 s53, 7340032
s_cselect_b32 s93, 7340032, 0
s_sub_u32 s53, s53, s93
s_waitcnt vmcnt(12)
s_mov_b32 s56, 0
L_nonce_9:
v_readfirstlane_b32 s26, v243
s_nop 3
s_cmp_lg_u32 s26, 0
s_cbranch_scc1 L_nonce_ok_10
global_load_dword v243, v242, s[22:23] sc1
s_waitcnt vmcnt(0)
s_add_u32 s56, s56, 1
s_cmp_lt_u32 s56, 262144
s_cbranch_scc1 L_nonce_9
L_nonce_ok_10:
s_barrier
s_cmp_lg_u32 s3, 0
s_cbranch_scc1 L_pub_11
s_lshl_b32 s56, s2, 7
s_add_u32 s56, s56, 8978432
s_mov_b64 exec, 1
v_mov_b32 v240, s26
v_mov_b32 v241, s56
global_store_dword v241, v240, s[24:25] sc1
s_mov_b64 exec, -1
L_pub_11:
s_add_u32 m0, s29, 22528
s_nop 0
buffer_load_dwordx4 v4, s[76:79], s53 offen  lds
buffer_load_dwordx4 v5, s[76:79], s53 offen offset:1024  lds
s_add_u32 s53, s53, s70
s_cmp_ge_u32 s53, 7340032
s_cselect_b32 s93, 7340032, 0
s_sub_u32 s53, s53, s93
s_add_u32 m0, s29, 24576
s_nop 0
buffer_load_dwordx4 v4, s[76:79], s53 offen  lds
buffer_load_dwordx4 v5, s[76:79], s53 offen offset:1024  lds
s_add_u32 s53, s53, s70
s_cmp_ge_u32 s53, 7340032
s_cselect_b32 s93, 7340032, 0
s_sub_u32 s53, s53, s93
s_add_u32 m0, s29, 26624
s_nop 0
buffer_load_dwordx4 v4, s[76:79], s53 offen  lds
buffer_load_dwordx4 v5, s[76:79], s53 offen offset:1024  lds
s_add_u32 s53, s53, s70
s_cmp_ge_u32 s53, 7340032
s_cselect_b32 s93, 7340032, 0
s_sub_u32 s53, s53, s93
s_add_u32 m0, s29, 28672
s_nop 0
buffer_load_dwordx4 v4, s[76:79], s53 offen  lds
buffer_load_dwordx4 v5, s[76:79], s53 offen offset:1024  lds
s_add_u32 s53, s53, s70
s_cmp_ge_u32 s53, 7340032
s_cselect_b32 s93, 7340032, 0
s_sub_u32 s53, s53, s93
s_add_u32 m0, s29, 30720
s_nop 0
buffer_load_dwordx4 v4, s[76:79], s53 offen  lds
buffer_load_dwordx4 v5, s[76:79], s53 offen offset:1024  lds
s_add_u32 s53, s53, s70
s_cmp_ge_u32 s53, 7340032
s_cselect_b32 s93, 7340032, 0
s_sub_u32 s53, s53, s93
s_add_u32 m0, s29, 32768
s_nop 0
buffer_load_dwordx4 v4, s[76:79], s53 offen  lds
buffer_load_dwordx4 v5, s[76:79], s53 offen offset:1024  lds
s_add_u32 s53, s53, s70
s_cmp_ge_u32 s53, 7340032
s_cselect_b32 s93, 7340032, 0
s_sub_u32 s53, s53, s93
s_add_u32 m0, s29, 34816
s_nop 0
buffer_load_dwordx4 v4, s[76:79], s53 offen  lds
buffer_load_dwordx4 v5, s[76:79], s53 offen offset:1024  lds
s_add_u32 s53, s53, s70
s_cmp_ge_u32 s53, 7340032
s_cselect_b32 s93, 7340032, 0
s_sub_u32 s53, s53, s93
s_waitcnt vmcnt(41)
ds_read_b64_tr_b16 a[0:1], v8 offset:0
ds_read_b64_tr_b16 a[2:3], v8 offset:512
ds_read_b64_tr_b16 a[4:5], v9 offset:0
ds_read_b64_tr_b16 a[6:7], v9 offset:512
s_waitcnt vmcnt(39)
ds_read_b64_tr_b16 a[8:9], v8 offset:2048
ds_read_b64_tr_b16 a[10:11], v8 offset:2560
ds_read_b64_tr_b16 a[12:13], v9 offset:2048
ds_read_b64_tr_b16 a[14:15], v9 offset:2560
s_waitcnt lgkmcnt(4)
s_add_u32 m0, s29, 0
s_nop 0
buffer_load_dwordx4 v4, s[76:79], s53 offen  lds
buffer_load_dwordx4 v5, s[76:79], s53 offen offset:1024  lds
s_add_u32 s53, s53, s70
s_cmp_ge_u32 s53, 7340032
s_cselect_b32 s93, 7340032, 0
s_sub_u32 s53, s53, s93
s_waitcnt vmcnt(39)
ds_read_b64_tr_b16 a[16:17], v8 offset:4096
ds_read_b64_tr_b16 a[18:19], v8 offset:4608
ds_read_b64_tr_b16 a[20:21], v9 offset:4096
ds_read_b64_tr_b16 a[22:23], v9 offset:4608
s_waitcnt lgkmcnt(4)
s_add_u32 m0, s29, 2048
s_nop 0
buffer_load_dwordx4 v4, s[76:79], s53 offen  lds
buffer_load_dwordx4 v5, s[76:79], s53 offen offset:1024  lds
s_add_u32 s53, s53, s70
s_cmp_ge_u32 s53, 7340032
s_cselect_b32 s93, 7340032, 0
s_sub_u32 s53, s53, s93
s_waitcnt vmcnt(39)
ds_read_b64_tr_b16 a[24:25], v8 offset:6144
ds_read_b64_tr_b16 a[26:27], v8 offset:6656
ds_read_b64_tr_b16 a[28:29], v9 offset:6144
ds_read_b64_tr_b16 a[30:31], v9 offset:6656
s_waitcnt lgkmcnt(4)
s_add_u32 m0, s29, 4096
s_nop 0
buffer_load_dwordx4 v4, s[76:79], s53 offen  lds
buffer_load_dwordx4 v5, s[76:79], s53 offen offset:1024  lds
s_add_u32 s53, s53, s70
s_cmp_ge_u32 s53, 7340032
s_cselect_b32 s93, 7340032, 0
s_sub_u32 s53, s53, s93
s_waitcnt vmcnt(39)
ds_read_b64_tr_b16 a[32:33], v8 offset:8192
ds_read_b64_tr_b16 a[34:35], v8 offset:8704
ds_read_b64_tr_b16 a[36:37], v9 offset:8192
ds_read_b64_tr_b16 a[38:39], v9 offset:8704
s_waitcnt lgkmcnt(4)
s_add_u32 m0, s29, 6144
s_nop 0
buffer_load_dwordx4 v4, s[76:79], s53 offen  lds
buffer_load_dwordx4 v5, s[76:79], s53 offen offset:1024  lds
s_add_u32 s53, s53, s70
s_cmp_ge_u32 s53, 7340032
s_cselect_b32 s93, 7340032, 0
s_sub_u32 s53, s53, s93
s_waitcnt vmcnt(32)
ds_read_b64_tr_b16 a[40:41], v8 offset:10240
ds_read_b64_tr_b16 a[42:43], v8 offset:10752
ds_read_b64_tr_b16 a[44:45], v9 offset:10240
ds_read_b64_tr_b16 a[46:47], v9 offset:10752
s_waitcnt lgkmcnt(4)
s_add_u32 m0, s29, 8192
s_nop 0
buffer_load_dwordx4 v4, s[76:79], s53 offen  lds
buffer_load_dwordx4 v5, s[76:79], s53 offen offset:1024  lds
s_add_u32 s53, s53, s70
s_cmp_ge_u32 s53, 7340032
s_cselect_b32 s93, 7340032, 0
s_sub_u32 s53, s53, s93
s_waitcnt vmcnt(32)
ds_read_b64_tr_b16 a[48:49], v8 offset:12288
ds_read_b64_tr_b16 a[50:51], v8 offset:12800
ds_read_b64_tr_b16 a[52:53], v9 offset:12288
ds_read_b64_tr_b16 a[54:55], v9 offset:12800
s_waitcnt lgkmcnt(4)
s_add_u32 m0, s29, 10240
s_nop 0
buffer_load_dwordx4 v4, s[76:79], s53 offen  lds
buffer_load_dwordx4 v5, s[76:79], s53 offen offset:1024  lds
s_add_u32 s53, s53, s70
s_cmp_ge_u32 s53, 7340032
s_cselect_b32 s93, 7340032, 0
s_sub_u32 s53, s53, s93
s_waitcnt vmcnt(32)
ds_read_b64_tr_b16 a[56:57], v8 offset:14336
ds_read_b64_tr_b16 a[58:59], v8 offset:14848
ds_read_b64_tr_b16 a[60:61], v9 offset:14336
ds_read_b64_tr_b16 a[62:63], v9 offset:14848
s_waitcnt lgkmcnt(4)
s_add_u32 m0, s29, 12288
s_nop 0
buffer_load_dwordx4 v4, s[76:79], s53 offen  lds
buffer_load_dwordx4 v5, s[76:79], s53 offen offset:1024  lds
s_add_u32 s53, s53, s70
s_cmp_ge_u32 s53, 7340032
s_cselect_b32 s93, 7340032, 0
s_sub_u32 s53, s53, s93
s_waitcnt vmcnt(32)
ds_read_b64_tr_b16 a[64:65], v8 offset:16384
ds_read_b64_tr_b16 a[66:67], v8 offset:16896
ds_read_b64_tr_b16 a[68:69], v9 offset:16384
ds_read_b64_tr_b16 a[70:71], v9 offset:16896
s_waitcnt lgkmcnt(4)
s_add_u32 m0, s29, 14336
s_nop 0
buffer_load_dwordx4 v4, s[76:79], s53 offen  lds
buffer_load_dwordx4 v5, s[76:79], s53 offen offset:1024  lds
s_add_u32 s53, s53, s70
s_cmp_ge_u32 s53, 7340032
s_cselect_b32 s93, 7340032, 0
s_sub_u32 s53, s53, s93
s_waitcnt vmcnt(32)
ds_read_b64_tr_b16 a[72:73], v8 offset:18432
ds_read_b64_tr_b16 a[74:75], v8 offset:18944
ds_read_b64_tr_b16 a[76:77], v9 offset:18432
ds_read_b64_tr_b16 a[78:79], v9 offset:18944
s_waitcnt lgkmcnt(4)
s_add_u32 m0, s29, 16384
s_nop 0
buffer_load_dwordx4 v4, s[76:79], s53 offen  lds
buffer_load_dwordx4 v5, s[76:79], s53 offen offset:1024  lds
s_add_u32 s53, s53, s70
s_cmp_ge_u32 s53, 7340032
s_cselect_b32 s93, 7340032, 0
s_sub_u32 s53, s53, s93
s_waitcnt vmcnt(32)
ds_read_b64_tr_b16 a[80:81], v8 offset:20480
ds_read_b64_tr_b16 a[82:83], v8 offset:20992
ds_read_b64_tr_b16 a[84:85], v9 offset:20480
ds_read_b64_tr_b16 a[86:87], v9 offset:20992
s_waitcnt lgkmcnt(4)
s_add_u32 m0, s29, 18432
s_nop 0
buffer_load_dwordx4 v4, s[76:79], s53 offen  lds
buffer_load_dwordx4 v5, s[76:79], s53 offen offset:1024  lds
s_add_u32 s53, s53, s70
s_cmp_ge_u32 s53, 7340032
s_cselect_b32 s93, 7340032, 0
s_sub_u32 s53, s53, s93
s_waitcnt vmcnt(32)
ds_read_b64_tr_b16 a[88:89], v8 offset:22528
ds_read_b64_tr_b16 a[90:91], v8 offset:23040
ds_read_b64_tr_b16 a[92:93], v9 offset:22528
ds_read_b64_tr_b16 a[94:95], v9 offset:23040
s_waitcnt lgkmcnt(4)
s_add_u32 m0, s29, 20480
s_nop 0
buffer_load_dwordx4 v4, s[76:79], s53 offen  lds
buffer_load_dwordx4 v5, s[76:79], s53 offen offset:1024  lds
s_add_u32 s53, s53, s70
s_cmp_ge_u32 s53, 7340032
s_cselect_b32 s93, 7340032, 0
s_sub_u32 s53, s53, s93
s_waitcnt vmcnt(32)
ds_read_b64_tr_b16 a[96:97], v8 offset:24576
ds_read_b64_tr_b16 a[98:99], v8 offset:25088
ds_read_b64_tr_b16 a[100:101], v9 offset:24576
ds_read_b64_tr_b16 a[102:103], v9 offset:25088
s_waitcnt lgkmcnt(4)
s_add_u32 m0, s29, 22528
s_nop 0
buffer_load_dwordx4 v4, s[76:79], s53 offen  lds
buffer_load_dwordx4 v5, s[76:79], s53 offen offset:1024  lds
s_add_u32 s53, s53, s70
s_cmp_ge_u32 s53, 7340032
s_cselect_b32 s93, 7340032, 0
s_sub_u32 s53, s53, s93
s_waitcnt vmcnt(32)
ds_read_b64_tr_b16 a[104:105], v8 offset:26624
ds_read_b64_tr_b16 a[106:107], v8 offset:27136
ds_read_b64_tr_b16 a[108:109], v9 offset:26624
ds_read_b64_tr_b16 a[110:111], v9 offset:27136
s_waitcnt lgkmcnt(4)
s_add_u32 m0, s29, 24576
s_nop 0
buffer_load_dwordx4 v4, s[76:79], s53 offen  lds
buffer_load_dwordx4 v5, s[76:79], s53 offen offset:1024  lds
s_add_u32 s53, s53, s70
s_cmp_ge_u32 s53, 7340032
s_cselect_b32 s93, 7340032, 0
s_sub_u32 s53, s53, s93
s_waitcnt vmcnt(32)
ds_read_b64_tr_b16 a[112:113], v8 offset:28672
ds_read_b64_tr_b16 a[114:115], v8 offset:29184
ds_read_b64_tr_b16 a[116:117], v9 offset:28672
ds_read_b64_tr_b16 a[118:119], v9 offset:29184
s_waitcnt lgkmcnt(4)
s_add_u32 m0, s29, 26624
s_nop 0
buffer_load_dwordx4 v4, s[76:79], s53 offen  lds
buffer_load_dwordx4 v5, s[76:79], s53 offen offset:1024  lds
s_add_u32 s53, s53, s70
s_cmp_ge_u32 s53, 7340032
s_cselect_b32 s93, 7340032, 0
s_sub_u32 s53, s53, s93
s_waitcnt vmcnt(32)
ds_read_b64_tr_b16 a[120:121], v8 offset:30720
ds_read_b64_tr_b16 a[122:123], v8 offset:31232
ds_read_b64_tr_b16 a[124:125], v9 offset:30720
ds_read_b64_tr_b16 a[126:127], v9 offset:31232
s_waitcnt lgkmcnt(4)
s_waitcnt vmcnt(30)
ds_read_b64_tr_b16 a[128:129], v8 offset:32768
ds_read_b64_tr_b16 a[130:131], v8 offset:33280
ds_read_b64_tr_b16 a[132:133], v9 offset:32768
ds_read_b64_tr_b16 a[134:135], v9 offset:33280
s_waitcnt lgkmcnt(4)
s_waitcnt vmcnt(28)
ds_read_b64_tr_b16 a[136:137], v8 offset:34816
ds_read_b64_tr_b16 a[138:139], v8 offset:35328
ds_read_b64_tr_b16 a[140:141], v9 offset:34816
ds_read_b64_tr_b16 a[142:143], v9 offset:35328
s_waitcnt lgkmcnt(4)
s_waitcnt vmcnt(26)
ds_read_b64_tr_b16 a[144:145], v8 offset:0
ds_read_b64_tr_b16 a[146:147], v8 offset:512
ds_read_b64_tr_b16 a[148:149], v9 offset:0
ds_read_b64_tr_b16 a[150:151], v9 offset:512
s_waitcnt lgkmcnt(4)
s_waitcnt vmcnt(24)
ds_read_b64_tr_b16 a[152:153], v8 offset:2048
ds_read_b64_tr_b16 a[154:155], v8 offset:2560
ds_read_b64_tr_b16 a[156:157], v9 offset:2048
ds_read_b64_tr_b16 a[158:159], v9 offset:2560
s_waitcnt lgkmcnt(4)
s_waitcnt vmcnt(22)
ds_read_b64_tr_b16 a[160:161], v8 offset:4096
ds_read_b64_tr_b16 a[162:163], v8 offset:4608
ds_read_b64_tr_b16 a[164:165], v9 offset:4096
ds_read_b64_tr_b16 a[166:167], v9 offset:4608
s_waitcnt lgkmcnt(4)
s_waitcnt vmcnt(20)
ds_read_b64_tr_b16 a[168:169], v8 offset:6144
ds_read_b64_tr_b16 a[170:171], v8 offset:6656
ds_read_b64_tr_b16 a[172:173], v9 offset:6144
ds_read_b64_tr_b16 a[174:175], v9 offset:6656
s_waitcnt lgkmcnt(4)
s_waitcnt vmcnt(18)
ds_read_b64_tr_b16 a[176:177], v8 offset:8192
ds_read_b64_tr_b16 a[178:179], v8 offset:8704
ds_read_b64_tr_b16 a[180:181], v9 offset:8192
ds_read_b64_tr_b16 a[182:183], v9 offset:8704
s_waitcnt lgkmcnt(4)
s_waitcnt vmcnt(16)
ds_read_b64_tr_b16 a[184:185], v8 offset:10240
ds_read_b64_tr_b16 a[186:187], v8 offset:10752
ds_read_b64_tr_b16 a[188:189], v9 offset:10240
ds_read_b64_tr_b16 a[190:191], v9 offset:10752
s_waitcnt lgkmcnt(4)
s_waitcnt vmcnt(14)
ds_read_b64_tr_b16 a[192:193], v8 offset:12288
ds_read_b64_tr_b16 a[194:195], v8 offset:12800
ds_read_b64_tr_b16 a[196:197], v9 offset:12288
ds_read_b64_tr_b16 a[198:199], v9 offset:12800
s_waitcnt lgkmcnt(4)
s_waitcnt vmcnt(12)
ds_read_b64_tr_b16 a[200:201], v8 offset:14336
ds_read_b64_tr_b16 a[202:203], v8 offset:14848
ds_read_b64_tr_b16 a[204:205], v9 offset:14336
ds_read_b64_tr_b16 a[206:207], v9 offset:14848
s_waitcnt lgkmcnt(4)
s_waitcnt vmcnt(10)
ds_read_b64_tr_b16 a[208:209], v8 offset:16384
ds_read_b64_tr_b16 a[210:211], v8 offset:16896
ds_read_b64_tr_b16 a[212:213], v9 offset:16384
ds_read_b64_tr_b16 a[214:215], v9 offset:16896
s_waitcnt lgkmcnt(4)
s_waitcnt vmcnt(8)
ds_read_b64_tr_b16 a[216:217], v8 offset:18432
ds_read_b64_tr_b16 a[218:219], v8 offset:18944
ds_read_b64_tr_b16 a[220:221], v9 offset:18432
ds_read_b64_tr_b16 a[222:223], v9 offset:18944
s_waitcnt lgkmcnt(4)
s_waitcnt vmcnt(6)
ds_read_b64_tr_b16 a[224:225], v8 offset:20480
ds_read_b64_tr_b16 a[226:227], v8 offset:20992
ds_read_b64_tr_b16 a[228:229], v9 offset:20480
ds_read_b64_tr_b16 a[230:231], v9 offset:20992
s_waitcnt lgkmcnt(4)
s_waitcnt vmcnt(4)
ds_read_b64_tr_b16 a[232:233], v8 offset:22528
ds_read_b64_tr_b16 a[234:235], v8 offset:23040
ds_read_b64_tr_b16 a[236:237], v9 offset:22528
ds_read_b64_tr_b16 a[238:239], v9 offset:23040
s_waitcnt lgkmcnt(4)
s_waitcnt vmcnt(2)
ds_read_b64_tr_b16 a[240:241], v8 offset:24576
ds_read_b64_tr_b16 a[242:243], v8 offset:25088
ds_read_b64_tr_b16 a[244:245], v9 offset:24576
ds_read_b64_tr_b16 a[246:247], v9 offset:25088
s_waitcnt lgkmcnt(4)
s_waitcnt vmcnt(0)
ds_read_b64_tr_b16 a[248:249], v8 offset:26624
ds_read_b64_tr_b16 a[250:251], v8 offset:27136
ds_read_b64_tr_b16 a[252:253], v9 offset:26624
ds_read_b64_tr_b16 a[254:255], v9 offset:27136
s_waitcnt lgkmcnt(4)
s_waitcnt lgkmcnt(0)
s_cmp_ge_u32 s28, 28
s_cbranch_scc1 L_noc_12
s_mov_b32 s36, s24
s_mov_b32 s37, s25
s_mov_b32 s38, 2097152
s_mov_b32 s39, 0x20000
s_lshl_b32 s57, s30, 7
v_lshrrev_b32 v44, 3, v1
v_and_b32 v45, 7, v1
v_lshlrev_b32 v46, 1, v44
v_and_b32 v46, 4, v46
v_xor_b32 v45, v45, v46
v_lshlrev_b32 v45, 4, v45
s_mov_b32 s56, 1024
v_mad_u32_u24 v2, v44, s56, v45
v_add_u32 v2, s57, v2
v_add_u32 v3, 7168, v2
s_mul_i32 s52, s3, 16384
s_lshl_b32 s56, s94, 16
s_add_u32 s52, s52, s56
s_lshr_b32 s56, s3, 1
s_lshl_b32 s56, s56, 5
s_lshl_b32 s57, s31, 6
s_add_u32 s56, s56, s57
v_and_b32 v44, 31, v1
v_add_u32 v44, s56, v44
v_lshlrev_b32 v44, 1, v44
global_load_ushort v60, v44, s[14:15]
s_lshr_b32 s56, s3, 1
s_lshl_b32 s56, s56, 5
s_lshl_b32 s57, s32, 6
s_add_u32 s56, s56, s57
v_and_b32 v44, 31, v1
v_add_u32 v44, s56, v44
s_and_b32 s56, s3, 1
s_lshl_b32 s56, s56, 6
s_lshl_b32 s57, s30, 7
s_add_u32 s56, s56, s57
v_lshrrev_b32 v45, 5, v1
v_lshlrev_b32 v45, 4, v45
v_lshl_add_u32 v50, v44, 10, v45
v_add_u32 v50, s56, v50
s_mov_b32 s40, s16
s_mov_b32 s41, s17
s_mov_b32 s42, 7340032
s_mov_b32 s43, 0x20000
s_lshl_b32 s57, s32, 7
v_lshrrev_b32 v44, 3, v1
v_and_b32 v45, 7, v1
v_lshlrev_b32 v46, 1, v44
v_and_b32 v46, 4, v46
v_xor_b32 v45, v45, v46
v_lshlrev_b32 v45, 4, v45
s_mov_b32 s56, 4096
v_mad_u32_u24 v4, v44, s56, v45
v_add_u32 v4, s57, v4
v_add_u32 v5, 31744, v4
s_mul_i32 s53, s3, 65536
s_mul_i32 s56, s95, 262144
s_add_u32 s53, s53, s56
s_branch L_nod_13
L_noc_12:
L_nod_13:
s_cmp_lg_u32 s3, 0
s_cbranch_scc1 L_poll_skip_14
s_mov_b32 s56, 8978432
v_and_b32 v128, 63, v0
v_lshlrev_b32 v128, 7, v128
v_add_u32 v128, s56, v128
v_and_b32 v130, 63, v0
v_lshlrev_b32 v130, 7, v130
v_add_u32 v130, s56, v130
v_add_u32 v130, 8192, v130
v_and_b32 v132, 63, v0
v_lshlrev_b32 v132, 7, v132
v_add_u32 v132, s56, v132
v_add_u32 v132, 16384, v132
v_and_b32 v134, 63, v0
v_lshlrev_b32 v134, 7, v134
v_add_u32 v134, s56, v134
v_add_u32 v134, 24576, v134
s_mov_b32 s57, 0
L_poll_15:
global_load_dword v129, v128, s[24:25] sc1
global_load_dword v131, v130, s[24:25] sc1
global_load_dword v133, v132, s[24:25] sc1
global_load_dword v135, v134, s[24:25] sc1
s_waitcnt vmcnt(0)
v_xor_b32 v129, s26, v129
v_xor_b32 v131, s26, v131
v_or_b32 v129, v129, v131
v_xor_b32 v133, s26, v133
v_or_b32 v129, v129, v133
v_xor_b32 v135, s26, v135
v_or_b32 v129, v129, v135
v_cmp_eq_u32 vcc, 0, v129
s_nop 4
s_cmp_eq_u64 vcc, -1
s_cbranch_scc1 L_poll_ok_16
s_add_u32 s57, s57, 1
s_cmp_lt_u32 s57, 262144
s_cbranch_scc1 L_poll_15
L_poll_ok_16:
L_poll_skip_14:
s_barrier
s_cmp_ge_u32 s28, 28
s_cbranch_scc1 L_fft_2
s_add_u32 m0, s29, 0
s_nop 0
buffer_load_dwordx4 v2, s[36:39], s52 offen  lds
buffer_load_dwordx4 v3, s[36:39], s52 offen offset:1024  lds
s_add_u32 s52, s52, 65536
s_cmp_ge_u32 s52, 2097152
s_cselect_b32 s93, 2097152, 0
s_sub_u32 s52, s52, s93
s_add_u32 m0, s29, 2048
s_nop 0
buffer_load_dwordx4 v2, s[36:39], s52 offen  lds
buffer_load_dwordx4 v3, s[36:39], s52 offen offset:1024  lds
s_add_u32 s52, s52, 65536
s_cmp_ge_u32 s52, 2097152
s_cselect_b32 s93, 2097152, 0
s_sub_u32 s52, s52, s93
s_add_u32 m0, s29, 4096
s_nop 0
buffer_load_dwordx4 v2, s[36:39], s52 offen  lds
buffer_load_dwordx4 v3, s[36:39], s52 offen offset:1024  lds
s_add_u32 s52, s52, 65536
s_cmp_ge_u32 s52, 2097152
s_cselect_b32 s93, 2097152, 0
s_sub_u32 s52, s52, s93
s_add_u32 m0, s29, 6144
s_nop 0
buffer_load_dwordx4 v2, s[36:39], s52 offen  lds
buffer_load_dwordx4 v3, s[36:39], s52 offen offset:1024  lds
s_add_u32 s52, s52, 65536
s_cmp_ge_u32 s52, 2097152
s_cselect_b32 s93, 2097152, 0
s_sub_u32 s52, s52, s93
s_and_b32 s62, s3, 1
s_lshl_b32 s62, s62, 5
s_lshl_b32 s63, s30, 6
s_add_u32 s62, s62, s63
v_and_b32 v36, 31, v1
v_add_u32 v36, s62, v36
v_xor_b32 v37, 32, v36
v_cvt_f32_u32 v36, v36
v_cvt_f32_u32 v37, v37
v_mul_f32 v36, 0x3b000000, v36
v_mul_f32 v37, 0x3b000000, v37
v_lshrrev_b32 v38, 5, v1
v_lshlrev_b32 v38, 2, v38
s_lshl_b32 s62, s3, 3
v_add_u32 v38, s62, v38
s_add_u32 s63, s96, 0
s_and_b32 s63, s63, 7
s_lshl_b32 s62, s63, 5
v_add_u32 v39, s62, v38
v_cvt_f32_u32 v39, v39
s_add_u32 s63, s63, 1
s_and_b32 s63, s63, 7
v_mul_f32 v40, v39, v36
v_mul_f32 v41, v39, v37
v_sin_f32 v42, v40
v_sin_f32 v43, v41
v_cos_f32 v40, v40
v_cos_f32 v41, v41
v_add_f32 v39, 1.0, v39
v_cvt_pk_bf16_f32 v192, v40, -v42
v_cvt_pk_bf16_f32 v196, v41, -v43
v_mul_f32 v40, v39, v36
v_mul_f32 v41, v39, v37
v_sin_f32 v42, v40
v_sin_f32 v43, v41
v_cos_f32 v40, v40
v_cos_f32 v41, v41
v_add_f32 v39, 1.0, v39
v_cvt_pk_bf16_f32 v193, v40, -v42
v_cvt_pk_bf16_f32 v197, v41, -v43
v_mul_f32 v40, v39, v36
v_mul_f32 v41, v39, v37
v_sin_f32 v42, v40
v_sin_f32 v43, v41
v_cos_f32 v40, v40
v_cos_f32 v41, v41
v_add_f32 v39, 1.0, v39
v_cvt_pk_bf16_f32 v194, v40, -v42
v_cvt_pk_bf16_f32 v198, v41, -v43
v_mul_f32 v40, v39, v36
v_mul_f32 v41, v39, v37
v_sin_f32 v42, v40
v_sin_f32 v43, v41
v_cos_f32 v40, v40
v_cos_f32 v41, v41
v_add_f32 v39, 1.0, v39
v_cvt_pk_bf16_f32 v195, v40, -v42
v_cvt_pk_bf16_f32 v199, v41, -v43
s_lshl_b32 s62, s63, 5
v_add_u32 v39, s62, v38
v_cvt_f32_u32 v39, v39
s_add_u32 s63, s63, 1
s_and_b32 s63, s63, 7
v_mul_f32 v40, v39, v36
v_mul_f32 v41, v39, v37
v_sin_f32 v42, v40
v_sin_f32 v43, v41
v_cos_f32 v40, v40
v_cos_f32 v41, v41
v_add_f32 v39, 1.0, v39
v_cvt_pk_bf16_f32 v200, v40, -v42
v_cvt_pk_bf16_f32 v204, v41, -v43
v_mul_f32 v40, v39, v36
v_mul_f32 v41, v39, v37
v_sin_f32 v42, v40
v_sin_f32 v43, v41
v_cos_f32 v40, v40
v_cos_f32 v41, v41
v_add_f32 v39, 1.0, v39
v_cvt_pk_bf16_f32 v201, v40, -v42
v_cvt_pk_bf16_f32 v205, v41, -v43
v_mul_f32 v40, v39, v36
v_mul_f32 v41, v39, v37
v_sin_f32 v42, v40
v_sin_f32 v43, v41
v_cos_f32 v40, v40
v_cos_f32 v41, v41
v_add_f32 v39, 1.0, v39
v_cvt_pk_bf16_f32 v202, v40, -v42
v_cvt_pk_bf16_f32 v206, v41, -v43
v_mul_f32 v40, v39, v36
v_mul_f32 v41, v39, v37
v_sin_f32 v42, v40
v_sin_f32 v43, v41
v_cos_f32 v40, v40
v_cos_f32 v41, v41
v_add_f32 v39, 1.0, v39
v_cvt_pk_bf16_f32 v203, v40, -v42
v_cvt_pk_bf16_f32 v207, v41, -v43
s_lshl_b32 s62, s63, 5
v_add_u32 v39, s62, v38
v_cvt_f32_u32 v39, v39
s_add_u32 s63, s63, 1
s_and_b32 s63, s63, 7
v_mul_f32 v40, v39, v36
v_mul_f32 v41, v39, v37
v_sin_f32 v42, v40
v_sin_f32 v43, v41
v_cos_f32 v40, v40
v_cos_f32 v41, v41
v_add_f32 v39, 1.0, v39
v_cvt_pk_bf16_f32 v208, v40, -v42
v_cvt_pk_bf16_f32 v212, v41, -v43
v_mul_f32 v40, v39, v36
v_mul_f32 v41, v39, v37
v_sin_f32 v42, v40
v_sin_f32 v43, v41
v_cos_f32 v40, v40
v_cos_f32 v41, v41
v_add_f32 v39, 1.0, v39
v_cvt_pk_bf16_f32 v209, v40, -v42
v_cvt_pk_bf16_f32 v213, v41, -v43
v_mul_f32 v40, v39, v36
v_mul_f32 v41, v39, v37
v_sin_f32 v42, v40
v_sin_f32 v43, v41
v_cos_f32 v40, v40
v_cos_f32 v41, v41
v_add_f32 v39, 1.0, v39
v_cvt_pk_bf16_f32 v210, v40, -v42
v_cvt_pk_bf16_f32 v214, v41, -v43
v_mul_f32 v40, v39, v36
v_mul_f32 v41, v39, v37
v_sin_f32 v42, v40
v_sin_f32 v43, v41
v_cos_f32 v40, v40
v_cos_f32 v41, v41
v_add_f32 v39, 1.0, v39
v_cvt_pk_bf16_f32 v211, v40, -v42
v_cvt_pk_bf16_f32 v215, v41, -v43
s_lshl_b32 s62, s63, 5
v_add_u32 v39, s62, v38
v_cvt_f32_u32 v39, v39
s_add_u32 s63, s63, 1
s_and_b32 s63, s63, 7
v_mul_f32 v40, v39, v36
v_mul_f32 v41, v39, v37
v_sin_f32 v42, v40
v_sin_f32 v43, v41
v_cos_f32 v40, v40
v_cos_f32 v41, v41
v_add_f32 v39, 1.0, v39
v_cvt_pk_bf16_f32 v216, v40, -v42
v_cvt_pk_bf16_f32 v220, v41, -v43
v_mul_f32 v40, v39, v36
v_mul_f32 v41, v39, v37
v_sin_f32 v42, v40
v_sin_f32 v43, v41
v_cos_f32 v40, v40
v_cos_f32 v41, v41
v_add_f32 v39, 1.0, v39
v_cvt_pk_bf16_f32 v217, v40, -v42
v_cvt_pk_bf16_f32 v221, v41, -v43
v_mul_f32 v40, v39, v36
v_mul_f32 v41, v39, v37
v_sin_f32 v42, v40
v_sin_f32 v43, v41
v_cos_f32 v40, v40
v_cos_f32 v41, v41
v_add_f32 v39, 1.0, v39
v_cvt_pk_bf16_f32 v218, v40, -v42
v_cvt_pk_bf16_f32 v222, v41, -v43
v_mul_f32 v40, v39, v36
v_mul_f32 v41, v39, v37
v_sin_f32 v42, v40
v_sin_f32 v43, v41
v_cos_f32 v40, v40
v_cos_f32 v41, v41
v_add_f32 v39, 1.0, v39
v_cvt_pk_bf16_f32 v219, v40, -v42
v_cvt_pk_bf16_f32 v223, v41, -v43
s_add_u32 m0, s29, 8192
s_nop 0
buffer_load_dwordx4 v2, s[36:39], s52 offen  lds
buffer_load_dwordx4 v3, s[36:39], s52 offen offset:1024  lds
s_add_u32 s52, s52, 65536
s_cmp_ge_u32 s52, 2097152
s_cselect_b32 s93, 2097152, 0
s_sub_u32 s52, s52, s93
s_add_u32 m0, s29, 10240
s_nop 0
buffer_load_dwordx4 v2, s[36:39], s52 offen  lds
buffer_load_dwordx4 v3, s[36:39], s52 offen offset:1024  lds
s_add_u32 s52, s52, 65536
s_cmp_ge_u32 s52, 2097152
s_cselect_b32 s93, 2097152, 0
s_sub_u32 s52, s52, s93
s_add_u32 m0, s29, 12288
s_nop 0
buffer_load_dwordx4 v2, s[36:39], s52 offen  lds
buffer_load_dwordx4 v3, s[36:39], s52 offen offset:1024  lds
s_add_u32 s52, s52, 65536
s_cmp_ge_u32 s52, 2097152
s_cselect_b32 s93, 2097152, 0
s_sub_u32 s52, s52, s93
s_add_u32 m0, s29, 14336
s_nop 0
buffer_load_dwordx4 v2, s[36:39], s52 offen  lds
buffer_load_dwordx4 v3, s[36:39], s52 offen offset:1024  lds
s_add_u32 s52, s52, 65536
s_cmp_ge_u32 s52, 2097152
s_cselect_b32 s93, 2097152, 0
s_sub_u32 s52, s52, s93
s_waitcnt vmcnt(14)
ds_read_b64_tr_b16 v[12:13], v6 offset:0
ds_read_b64_tr_b16 v[14:15], v6 offset:512
ds_read_b64_tr_b16 v[16:17], v7 offset:0
ds_read_b64_tr_b16 v[18:19], v7 offset:512
s_waitcnt vmcnt(12)
ds_read_b64_tr_b16 v[20:21], v6 offset:2048
ds_read_b64_tr_b16 v[22:23], v6 offset:2560
ds_read_b64_tr_b16 v[24:25], v7 offset:2048
ds_read_b64_tr_b16 v[26:27], v7 offset:2560
s_waitcnt lgkmcnt(4)
v_mfma_f32_32x32x16_bf16 v[64:79], v[12:15], a[0:3], 0
s_add_u32 m0, s29, 16384
s_nop 0
buffer_load_dwordx4 v2, s[36:39], s52 offen  lds
v_mfma_f32_32x32x16_bf16 v[80:95], v[16:19], a[0:3], 0
buffer_load_dwordx4 v3, s[36:39], s52 offen offset:1024  lds
s_add_u32 s52, s52, 65536
s_cmp_ge_u32 s52, 2097152
s_cselect_b32 s93, 2097152, 0
s_sub_u32 s52, s52, s93
s_waitcnt vmcnt(12)
v_mfma_f32_32x32x16_bf16 v[96:111], v[12:15], a[4:7], 0
ds_read_b64_tr_b16 v[28:29], v6 offset:4096
ds_read_b64_tr_b16 v[30:31], v6 offset:4608
v_mfma_f32_32x32x16_bf16 v[112:127], v[16:19], a[4:7], 0
ds_read_b64_tr_b16 v[32:33], v7 offset:4096
ds_read_b64_tr_b16 v[34:35], v7 offset:4608
s_waitcnt lgkmcnt(4)
v_mfma_f32_32x32x16_bf16 v[64:79], v[20:23], a[8:11], v[64:79]
s_add_u32 m0, s29, 18432
s_nop 0
buffer_load_dwordx4 v2, s[36:39], s52 offen  lds
v_mfma_f32_32x32x16_bf16 v[80:95], v[24:27], a[8:11], v[80:95]
buffer_load_dwordx4 v3, s[36:39], s52 offen offset:1024  lds
s_add_u32 s52, s52, 65536
s_cmp_ge_u32 s52, 2097152
s_cselect_b32 s93, 2097152, 0
s_sub_u32 s52, s52, s93
s_waitcnt vmcnt(12)
v_mfma_f32_32x32x16_bf16 v[96:111], v[20:23], a[12:15], v[96:111]
ds_read_b64_tr_b16 v[12:13], v6 offset:6144
ds_read_b64_tr_b16 v[14:15], v6 offset:6656
v_mfma_f32_32x32x16_bf16 v[112:127], v[24:27], a[12:15], v[112:127]
ds_read_b64_tr_b16 v[16:17], v7 offset:6144
ds_read_b64_tr_b16 v[18:19], v7 offset:6656
s_waitcnt lgkmcnt(4)
v_mfma_f32_32x32x16_bf16 v[64:79], v[28:31], a[16:19], v[64:79]
s_add_u32 m0, s29, 20480
s_nop 0
buffer_load_dwordx4 v2, s[36:39], s52 offen  lds
v_mfma_f32_32x32x16_bf16 v[80:95], v[32:35], a[16:19], v[80:95]
buffer_load_dwordx4 v3, s[36:39], s52 offen offset:1024  lds
s_add_u32 s52, s52, 65536
s_cmp_ge_u32 s52, 2097152
s_cselect_b32 s93, 2097152, 0
s_sub_u32 s52, s52, s93
s_waitcnt vmcnt(12)
v_mfma_f32_32x32x16_bf16 v[96:111], v[28:31], a[20:23], v[96:111]
ds_read_b64_tr_b16 v[20:21], v6 offset:8192
ds_read_b64_tr_b16 v[22:23], v6 offset:8704
v_mfma_f32_32x32x16_bf16 v[112:127], v[32:35], a[20:23], v[112:127]
ds_read_b64_tr_b16 v[24:25], v7 offset:8192
ds_read_b64_tr_b16 v[26:27], v7 offset:8704
s_waitcnt lgkmcnt(4)
v_mfma_f32_32x32x16_bf16 v[64:79], v[12:15], a[24:27], v[64:79]
s_add_u32 m0, s29, 22528
s_nop 0
buffer_load_dwordx4 v2, s[36:39], s52 offen  lds
v_mfma_f32_32x32x16_bf16 v[80:95], v[16:19], a[24:27], v[80:95]
buffer_load_dwordx4 v3, s[36:39], s52 offen offset:1024  lds
s_add_u32 s52, s52, 65536
s_cmp_ge_u32 s52, 2097152
s_cselect_b32 s93, 2097152, 0
s_sub_u32 s52, s52, s93
s_waitcnt vmcnt(12)
v_mfma_f32_32x32x16_bf16 v[96:111], v[12:15], a[28:31], v[96:111]
ds_read_b64_tr_b16 v[28:29], v6 offset:10240
ds_read_b64_tr_b16 v[30:31], v6 offset:10752
v_mfma_f32_32x32x16_bf16 v[112:127], v[16:19], a[28:31], v[112:127]
ds_read_b64_tr_b16 v[32:33], v7 offset:10240
ds_read_b64_tr_b16 v[34:35], v7 offset:10752
s_waitcnt lgkmcnt(4)
v_mfma_f32_32x32x16_bf16 v[64:79], v[20:23], a[32:35], v[64:79]
s_add_u32 m0, s29, 24576
s_nop 0
buffer_load_dwordx4 v2, s[36:39], s52 offen  lds
v_mfma_f32_32x32x16_bf16 v[80:95], v[24:27], a[32:35], v[80:95]
buffer_load_dwordx4 v3, s[36:39], s52 offen offset:1024  lds
s_add_u32 s52, s52, 65536
s_cmp_ge_u32 s52, 2097152
s_cselect_b32 s93, 2097152, 0
s_sub_u32 s52, s52, s93
s_waitcnt vmcnt(12)
v_mfma_f32_32x32x16_bf16 v[96:111], v[20:23], a[36:39], v[96:111]
ds_read_b64_tr_b16 v[12:13], v6 offset:12288
ds_read_b64_tr_b16 v[14:15], v6 offset:12800
v_mfma_f32_32x32x16_bf16 v[112:127], v[24:27], a[36:39], v[112:127]
ds_read_b64_tr_b16 v[16:17], v7 offset:12288
ds_read_b64_tr_b16 v[18:19], v7 offset:12800
s_waitcnt lgkmcnt(4)
v_mfma_f32_32x32x16_bf16 v[64:79], v[28:31], a[40:43], v[64:79]
s_add_u32 m0, s29, 26624
s_nop 0
buffer_load_dwordx4 v2, s[36:39], s52 offen  lds
v_mfma_f32_32x32x16_bf16 v[80:95], v[32:35], a[40:43], v[80:95]
buffer_load_dwordx4 v3, s[36:39], s52 offen offset:1024  lds
s_add_u32 s52, s52, 65536
s_cmp_ge_u32 s52, 2097152
s_cselect_b32 s93, 2097152, 0
s_sub_u32 s52, s52, s93
s_waitcnt vmcnt(12)
v_mfma_f32_32x32x16_bf16 v[96:111], v[28:31], a[44:47], v[96:111]
ds_read_b64_tr_b16 v[20:21], v6 offset:14336
ds_read_b64_tr_b16 v[22:23], v6 offset:14848
v_mfma_f32_32x32x16_bf16 v[112:127], v[32:35], a[44:47], v[112:127]
ds_read_b64_tr_b16 v[24:25], v7 offset:14336
ds_read_b64_tr_b16 v[26:27], v7 offset:14848
s_waitcnt lgkmcnt(4)
v_mfma_f32_32x32x16_bf16 v[64:79], v[12:15], a[48:51], v[64:79]
s_add_u32 m0, s29, 28672
s_nop 0
buffer_load_dwordx4 v2, s[36:39], s52 offen  lds
v_mfma_f32_32x32x16_bf16 v[80:95], v[16:19], a[48:51], v[80:95]
buffer_load_dwordx4 v3, s[36:39], s52 offen offset:1024  lds
s_add_u32 s52, s52, 65536
s_cmp_ge_u32 s52, 2097152
s_cselect_b32 s93, 2097152, 0
s_sub_u32 s52, s52, s93
s_waitcnt vmcnt(12)
v_mfma_f32_32x32x16_bf16 v[96:111], v[12:15], a[52:55], v[96:111]
ds_read_b64_tr_b16 v[28:29], v6 offset:16384
ds_read_b64_tr_b16 v[30:31], v6 offset:16896
v_mfma_f32_32x32x16_bf16 v[112:127], v[16:19], a[52:55], v[112:127]
ds_read_b64_tr_b16 v[32:33], v7 offset:16384
ds_read_b64_tr_b16 v[34:35], v7 offset:16896
s_waitcnt lgkmcnt(4)
v_mfma_f32_32x32x16_bf16 v[64:79], v[20:23], a[56:59], v[64:79]
s_add_u32 m0, s29, 30720
s_nop 0
buffer_load_dwordx4 v2, s[36:39], s52 offen  lds
v_mfma_f32_32x32x16_bf16 v[80:95], v[24:27], a[56:59], v[80:95]
buffer_load_dwordx4 v3, s[36:39], s52 offen offset:1024  lds
s_add_u32 s52, s52, 65536
s_cmp_ge_u32 s52, 2097152
s_cselect_b32 s93, 2097152, 0
s_sub_u32 s52, s52, s93
s_waitcnt vmcnt(12)
v_mfma_f32_32x32x16_bf16 v[96:111], v[20:23], a[60:63], v[96:111]
ds_read_b64_tr_b16 v[12:13], v6 offset:18432
ds_read_b64_tr_b16 v[14:15], v6 offset:18944
v_mfma_f32_32x32x16_bf16 v[112:127], v[24:27], a[60:63], v[112:127]
ds_read_b64_tr_b16 v[16:17], v7 offset:18432
ds_read_b64_tr_b16 v[18:19], v7 offset:18944
s_waitcnt lgkmcnt(4)
v_mfma_f32_32x32x16_bf16 v[64:79], v[28:31], a[64:67], v[64:79]
s_add_u32 m0, s29, 32768
s_nop 0
buffer_load_dwordx4 v2, s[36:39], s52 offen  lds
v_mfma_f32_32x32x16_bf16 v[80:95], v[32:35], a[64:67], v[80:95]
buffer_load_dwordx4 v3, s[36:39], s52 offen offset:1024  lds
s_add_u32 s52, s52, 65536
s_cmp_ge_u32 s52, 2097152
s_cselect_b32 s93, 2097152, 0
s_sub_u32 s52, s52, s93
s_waitcnt vmcnt(12)
v_mfma_f32_32x32x16_bf16 v[96:111], v[28:31], a[68:71], v[96:111]
ds_read_b64_tr_b16 v[20:21], v6 offset:20480
ds_read_b64_tr_b16 v[22:23], v6 offset:20992
v_mfma_f32_32x32x16_bf16 v[112:127], v[32:35], a[68:71], v[112:127]
ds_read_b64_tr_b16 v[24:25], v7 offset:20480
ds_read_b64_tr_b16 v[26:27], v7 offset:20992
s_waitcnt lgkmcnt(4)
v_mfma_f32_32x32x16_bf16 v[64:79], v[12:15], a[72:75], v[64:79]
s_add_u32 m0, s29, 34816
s_nop 0
buffer_load_dwordx4 v2, s[36:39], s52 offen  lds
v_mfma_f32_32x32x16_bf16 v[80:95], v[16:19], a[72:75], v[80:95]
buffer_load_dwordx4 v3, s[36:39], s52 offen offset:1024  lds
s_add_u32 s52, s52, 65536
s_cmp_ge_u32 s52, 2097152
s_cselect_b32 s93, 2097152, 0
s_sub_u32 s52, s52, s93
s_waitcnt vmcnt(12)
v_mfma_f32_32x32x16_bf16 v[96:111], v[12:15], a[76:79], v[96:111]
ds_read_b64_tr_b16 v[28:29], v6 offset:22528
ds_read_b64_tr_b16 v[30:31], v6 offset:23040
v_mfma_f32_32x32x16_bf16 v[112:127], v[16:19], a[76:79], v[112:127]
ds_read_b64_tr_b16 v[32:33], v7 offset:22528
ds_read_b64_tr_b16 v[34:35], v7 offset:23040
s_waitcnt lgkmcnt(4)
v_mfma_f32_32x32x16_bf16 v[64:79], v[20:23], a[80:83], v[64:79]
s_add_u32 m0, s29, 0
s_nop 0
buffer_load_dwordx4 v2, s[36:39], s52 offen  lds
v_mfma_f32_32x32x16_bf16 v[80:95], v[24:27], a[80:83], v[80:95]
buffer_load_dwordx4 v3, s[36:39], s52 offen offset:1024  lds
s_add_u32 s52, s52, 65536
s_cmp_ge_u32 s52, 2097152
s_cselect_b32 s93, 2097152, 0
s_sub_u32 s52, s52, s93
s_waitcnt vmcnt(12)
v_mfma_f32_32x32x16_bf16 v[96:111], v[20:23], a[84:87], v[96:111]
ds_read_b64_tr_b16 v[12:13], v6 offset:24576
ds_read_b64_tr_b16 v[14:15], v6 offset:25088
v_mfma_f32_32x32x16_bf16 v[112:127], v[24:27], a[84:87], v[112:127]
ds_read_b64_tr_b16 v[16:17], v7 offset:24576
ds_read_b64_tr_b16 v[18:19], v7 offset:25088
s_waitcnt lgkmcnt(4)
v_mfma_f32_32x32x16_bf16 v[64:79], v[28:31], a[88:91], v[64:79]
s_add_u32 m0, s29, 2048
s_nop 0
buffer_load_dwordx4 v2, s[36:39], s52 offen  lds
v_mfma_f32_32x32x16_bf16 v[80:95], v[32:35], a[88:91], v[80:95]
buffer_load_dwordx4 v3, s[36:39], s52 offen offset:1024  lds
s_add_u32 s52, s52, 65536
s_cmp_ge_u32 s52, 2097152
s_cselect_b32 s93, 2097152, 0
s_sub_u32 s52, s52, s93
s_waitcnt vmcnt(12)
v_mfma_f32_32x32x16_bf16 v[96:111], v[28:31], a[92:95], v[96:111]
ds_read_b64_tr_b16 v[20:21], v6 offset:26624
ds_read_b64_tr_b16 v[22:23], v6 offset:27136
v_mfma_f32_32x32x16_bf16 v[112:127], v[32:35], a[92:95], v[112:127]
ds_read_b64_tr_b16 v[24:25], v7 offset:26624
ds_read_b64_tr_b16 v[26:27], v7 offset:27136
s_waitcnt lgkmcnt(4)
v_mfma_f32_32x32x16_bf16 v[64:79], v[12:15], a[96:99], v[64:79]
s_add_u32 m0, s29, 4096
s_nop 0
buffer_load_dwordx4 v2, s[36:39], s52 offen  lds
v_mfma_f32_32x32x16_bf16 v[80:95], v[16:19], a[96:99], v[80:95]
buffer_load_dwordx4 v3, s[36:39], s52 offen offset:1024  lds
s_add_u32 s52, s52, 65536
s_cmp_ge_u32 s52, 2097152
s_cselect_b32 s93, 2097152, 0
s_sub_u32 s52, s52, s93
s_waitcnt vmcnt(12)
v_mfma_f32_32x32x16_bf16 v[96:111], v[12:15], a[100:103], v[96:111]
ds_read_b64_tr_b16 v[28:29], v6 offset:28672
ds_read_b64_tr_b16 v[30:31], v6 offset:29184
v_mfma_f32_32x32x16_bf16 v[112:127], v[16:19], a[100:103], v[112:127]
ds_read_b64_tr_b16 v[32:33], v7 offset:28672
ds_read_b64_tr_b16 v[34:35], v7 offset:29184
s_waitcnt lgkmcnt(4)
v_mfma_f32_32x32x16_bf16 v[64:79], v[20:23], a[104:107], v[64:79]
s_add_u32 m0, s29, 6144
s_nop 0
buffer_load_dwordx4 v2, s[36:39], s52 offen  lds
v_mfma_f32_32x32x16_bf16 v[80:95], v[24:27], a[104:107], v[80:95]
buffer_load_dwordx4 v3, s[36:39], s52 offen offset:1024  lds
s_add_u32 s52, s52, 65536
s_cmp_ge_u32 s52, 2097152
s_cselect_b32 s93, 2097152, 0
s_sub_u32 s52, s52, s93
s_waitcnt vmcnt(12)
v_mfma_f32_32x32x16_bf16 v[96:111], v[20:23], a[108:111], v[96:111]
ds_read_b64_tr_b16 v[12:13], v6 offset:30720
ds_read_b64_tr_b16 v[14:15], v6 offset:31232
v_mfma_f32_32x32x16_bf16 v[112:127], v[24:27], a[108:111], v[112:127]
ds_read_b64_tr_b16 v[16:17], v7 offset:30720
ds_read_b64_tr_b16 v[18:19], v7 offset:31232
s_waitcnt lgkmcnt(4)
v_mfma_f32_32x32x16_bf16 v[64:79], v[28:31], a[112:115], v[64:79]
s_add_u32 m0, s29, 8192
s_nop 0
buffer_load_dwordx4 v2, s[36:39], s52 offen  lds
v_mfma_f32_32x32x16_bf16 v[80:95], v[32:35], a[112:115], v[80:95]
buffer_load_dwordx4 v3, s[36:39], s52 offen offset:1024  lds
s_add_u32 s52, s52, 65536
s_cmp_ge_u32 s52, 2097152
s_cselect_b32 s93, 2097152, 0
s_sub_u32 s52, s52, s93
s_waitcnt vmcnt(12)
v_mfma_f32_32x32x16_bf16 v[96:111], v[28:31], a[116:119], v[96:111]
ds_read_b64_tr_b16 v[20:21], v6 offset:32768
ds_read_b64_tr_b16 v[22:23], v6 offset:33280
v_mfma_f32_32x32x16_bf16 v[112:127], v[32:35], a[116:119], v[112:127]
ds_read_b64_tr_b16 v[24:25], v7 offset:32768
ds_read_b64_tr_b16 v[26:27], v7 offset:33280
s_waitcnt lgkmcnt(4)
v_mfma_f32_32x32x16_bf16 v[64:79], v[12:15], a[120:123], v[64:79]
s_add_u32 m0, s29, 10240
s_nop 0
buffer_load_dwordx4 v2, s[36:39], s52 offen  lds
v_mfma_f32_32x32x16_bf16 v[80:95], v[16:19], a[120:123], v[80:95]
buffer_load_dwordx4 v3, s[36:39], s52 offen offset:1024  lds
s_add_u32 s52, s52, 65536
s_cmp_ge_u32 s52, 2097152
s_cselect_b32 s93, 2097152, 0
s_sub_u32 s52, s52, s93
s_waitcnt vmcnt(12)
v_mfma_f32_32x32x16_bf16 v[96:111], v[12:15], a[124:127], v[96:111]
ds_read_b64_tr_b16 v[28:29], v6 offset:34816
ds_read_b64_tr_b16 v[30:31], v6 offset:35328
v_mfma_f32_32x32x16_bf16 v[112:127], v[16:19], a[124:127], v[112:127]
ds_read_b64_tr_b16 v[32:33], v7 offset:34816
ds_read_b64_tr_b16 v[34:35], v7 offset:35328
s_waitcnt lgkmcnt(4)
v_mfma_f32_32x32x16_bf16 v[64:79], v[20:23], a[128:131], v[64:79]
s_add_u32 m0, s29, 12288
s_nop 0
buffer_load_dwordx4 v2, s[36:39], s52 offen  lds
v_mfma_f32_32x32x16_bf16 v[80:95], v[24:27], a[128:131], v[80:95]
buffer_load_dwordx4 v3, s[36:39], s52 offen offset:1024  lds
s_add_u32 s52, s52, 65536
s_cmp_ge_u32 s52, 2097152
s_cselect_b32 s93, 2097152, 0
s_sub_u32 s52, s52, s93
s_waitcnt vmcnt(12)
v_mfma_f32_32x32x16_bf16 v[96:111], v[20:23], a[132:135], v[96:111]
ds_read_b64_tr_b16 v[12:13], v6 offset:0
ds_read_b64_tr_b16 v[14:15], v6 offset:512
v_mfma_f32_32x32x16_bf16 v[112:127], v[24:27], a[132:135], v[112:127]
ds_read_b64_tr_b16 v[16:17], v7 offset:0
ds_read_b64_tr_b16 v[18:19], v7 offset:512
s_waitcnt lgkmcnt(4)
v_mfma_f32_32x32x16_bf16 v[64:79], v[28:31], a[136:139], v[64:79]
s_add_u32 m0, s29, 14336
s_nop 0
buffer_load_dwordx4 v2, s[36:39], s52 offen  lds
v_mfma_f32_32x32x16_bf16 v[80:95], v[32:35], a[136:139], v[80:95]
buffer_load_dwordx4 v3, s[36:39], s52 offen offset:1024  lds
s_add_u32 s52, s52, 65536
s_cmp_ge_u32 s52, 2097152
s_cselect_b32 s93, 2097152, 0
s_sub_u32 s52, s52, s93
s_waitcnt vmcnt(12)
v_mfma_f32_32x32x16_bf16 v[96:111], v[28:31], a[140:143], v[96:111]
ds_read_b64_tr_b16 v[20:21], v6 offset:2048
ds_read_b64_tr_b16 v[22:23], v6 offset:2560
v_mfma_f32_32x32x16_bf16 v[112:127], v[32:35], a[140:143], v[112:127]
ds_read_b64_tr_b16 v[24:25], v7 offset:2048
ds_read_b64_tr_b16 v[26:27], v7 offset:2560
s_waitcnt lgkmcnt(4)
v_mfma_f32_32x32x16_bf16 v[64:79], v[12:15], a[144:147], v[64:79]
s_add_u32 m0, s29, 16384
s_nop 0
buffer_load_dwordx4 v2, s[36:39], s52 offen  lds
v_mfma_f32_32x32x16_bf16 v[80:95], v[16:19], a[144:147], v[80:95]
buffer_load_dwordx4 v3, s[36:39], s52 offen offset:1024  lds
s_add_u32 s52, s52, 65536
s_cmp_ge_u32 s52, 2097152
s_cselect_b32 s93, 2097152, 0
s_sub_u32 s52, s52, s93
s_waitcnt vmcnt(12)
v_mfma_f32_32x32x16_bf16 v[96:111], v[12:15], a[148:151], v[96:111]
ds_read_b64_tr_b16 v[28:29], v6 offset:4096
ds_read_b64_tr_b16 v[30:31], v6 offset:4608
v_mfma_f32_32x32x16_bf16 v[112:127], v[16:19], a[148:151], v[112:127]
ds_read_b64_tr_b16 v[32:33], v7 offset:4096
ds_read_b64_tr_b16 v[34:35], v7 offset:4608
s_waitcnt lgkmcnt(4)
v_mfma_f32_32x32x16_bf16 v[64:79], v[20:23], a[152:155], v[64:79]
s_add_u32 m0, s29, 18432
s_nop 0
buffer_load_dwordx4 v2, s[36:39], s52 offen  lds
v_mfma_f32_32x32x16_bf16 v[80:95], v[24:27], a[152:155], v[80:95]
buffer_load_dwordx4 v3, s[36:39], s52 offen offset:1024  lds
s_add_u32 s52, s52, 65536
s_cmp_ge_u32 s52, 2097152
s_cselect_b32 s93, 2097152, 0
s_sub_u32 s52, s52, s93
s_waitcnt vmcnt(12)
v_mfma_f32_32x32x16_bf16 v[96:111], v[20:23], a[156:159], v[96:111]
ds_read_b64_tr_b16 v[12:13], v6 offset:6144
ds_read_b64_tr_b16 v[14:15], v6 offset:6656
v_mfma_f32_32x32x16_bf16 v[112:127], v[24:27], a[156:159], v[112:127]
ds_read_b64_tr_b16 v[16:17], v7 offset:6144
ds_read_b64_tr_b16 v[18:19], v7 offset:6656
s_waitcnt lgkmcnt(4)
v_mfma_f32_32x32x16_bf16 v[64:79], v[28:31], a[160:163], v[64:79]
s_add_u32 m0, s29, 20480
s_nop 0
buffer_load_dwordx4 v2, s[36:39], s52 offen  lds
v_mfma_f32_32x32x16_bf16 v[80:95], v[32:35], a[160:163], v[80:95]
buffer_load_dwordx4 v3, s[36:39], s52 offen offset:1024  lds
s_add_u32 s52, s52, 65536
s_cmp_ge_u32 s52, 2097152
s_cselect_b32 s93, 2097152, 0
s_sub_u32 s52, s52, s93
s_waitcnt vmcnt(12)
v_mfma_f32_32x32x16_bf16 v[96:111], v[28:31], a[164:167], v[96:111]
ds_read_b64_tr_b16 v[20:21], v6 offset:8192
ds_read_b64_tr_b16 v[22:23], v6 offset:8704
v_mfma_f32_32x32x16_bf16 v[112:127], v[32:35], a[164:167], v[112:127]
ds_read_b64_tr_b16 v[24:25], v7 offset:8192
ds_read_b64_tr_b16 v[26:27], v7 offset:8704
s_waitcnt lgkmcnt(4)
v_mfma_f32_32x32x16_bf16 v[64:79], v[12:15], a[168:171], v[64:79]
s_add_u32 m0, s29, 22528
s_nop 0
buffer_load_dwordx4 v2, s[36:39], s52 offen  lds
v_mfma_f32_32x32x16_bf16 v[80:95], v[16:19], a[168:171], v[80:95]
buffer_load_dwordx4 v3, s[36:39], s52 offen offset:1024  lds
s_add_u32 s52, s52, 65536
s_cmp_ge_u32 s52, 2097152
s_cselect_b32 s93, 2097152, 0
s_sub_u32 s52, s52, s93
s_waitcnt vmcnt(12)
v_mfma_f32_32x32x16_bf16 v[96:111], v[12:15], a[172:175], v[96:111]
ds_read_b64_tr_b16 v[28:29], v6 offset:10240
ds_read_b64_tr_b16 v[30:31], v6 offset:10752
v_mfma_f32_32x32x16_bf16 v[112:127], v[16:19], a[172:175], v[112:127]
ds_read_b64_tr_b16 v[32:33], v7 offset:10240
ds_read_b64_tr_b16 v[34:35], v7 offset:10752
s_waitcnt lgkmcnt(4)
v_mfma_f32_32x32x16_bf16 v[64:79], v[20:23], a[176:179], v[64:79]
s_add_u32 m0, s29, 24576
s_nop 0
buffer_load_dwordx4 v2, s[36:39], s52 offen  lds
v_mfma_f32_32x32x16_bf16 v[80:95], v[24:27], a[176:179], v[80:95]
buffer_load_dwordx4 v3, s[36:39], s52 offen offset:1024  lds
s_add_u32 s52, s52, 65536
s_cmp_ge_u32 s52, 2097152
s_cselect_b32 s93, 2097152, 0
s_sub_u32 s52, s52, s93
s_waitcnt vmcnt(12)
v_mfma_f32_32x32x16_bf16 v[96:111], v[20:23], a[180:183], v[96:111]
ds_read_b64_tr_b16 v[12:13], v6 offset:12288
ds_read_b64_tr_b16 v[14:15], v6 offset:12800
v_mfma_f32_32x32x16_bf16 v[112:127], v[24:27], a[180:183], v[112:127]
ds_read_b64_tr_b16 v[16:17], v7 offset:12288
ds_read_b64_tr_b16 v[18:19], v7 offset:12800
s_waitcnt lgkmcnt(4)
v_mfma_f32_32x32x16_bf16 v[64:79], v[28:31], a[184:187], v[64:79]
s_add_u32 m0, s29, 26624
s_nop 0
buffer_load_dwordx4 v2, s[36:39], s52 offen  lds
v_mfma_f32_32x32x16_bf16 v[80:95], v[32:35], a[184:187], v[80:95]
buffer_load_dwordx4 v3, s[36:39], s52 offen offset:1024  lds
s_add_u32 s52, s52, 65536
s_cmp_ge_u32 s52, 2097152
s_cselect_b32 s93, 2097152, 0
s_sub_u32 s52, s52, s93
s_waitcnt vmcnt(12)
v_mfma_f32_32x32x16_bf16 v[96:111], v[28:31], a[188:191], v[96:111]
ds_read_b64_tr_b16 v[20:21], v6 offset:14336
ds_read_b64_tr_b16 v[22:23], v6 offset:14848
v_mfma_f32_32x32x16_bf16 v[112:127], v[32:35], a[188:191], v[112:127]
ds_read_b64_tr_b16 v[24:25], v7 offset:14336
ds_read_b64_tr_b16 v[26:27], v7 offset:14848
s_waitcnt lgkmcnt(4)
v_mfma_f32_32x32x16_bf16 v[64:79], v[12:15], a[192:195], v[64:79]
v_lshrrev_b32 v45, 9, v50
v_and_b32 v45, 0xfffffffe, v45
global_load_ushort v176, v45, s[18:19]
global_load_dwordx4 v[168:171], v50, s[4:5]
global_load_dwordx4 v[172:175], v50, s[4:5] offset:32
v_mfma_f32_32x32x16_bf16 v[80:95], v[16:19], a[192:195], v[80:95]
s_waitcnt vmcnt(13)
v_mfma_f32_32x32x16_bf16 v[96:111], v[12:15], a[196:199], v[96:111]
ds_read_b64_tr_b16 v[28:29], v6 offset:16384
ds_read_b64_tr_b16 v[30:31], v6 offset:16896
v_mfma_f32_32x32x16_bf16 v[112:127], v[16:19], a[196:199], v[112:127]
ds_read_b64_tr_b16 v[32:33], v7 offset:16384
ds_read_b64_tr_b16 v[34:35], v7 offset:16896
s_waitcnt lgkmcnt(4)
v_mfma_f32_32x32x16_bf16 v[64:79], v[20:23], a[200:203], v[64:79]
v_mfma_f32_32x32x16_bf16 v[80:95], v[24:27], a[200:203], v[80:95]
s_waitcnt vmcnt(11)
v_mfma_f32_32x32x16_bf16 v[96:111], v[20:23], a[204:207], v[96:111]
ds_read_b64_tr_b16 v[12:13], v6 offset:18432
ds_read_b64_tr_b16 v[14:15], v6 offset:18944
v_mfma_f32_32x32x16_bf16 v[112:127], v[24:27], a[204:207], v[112:127]
ds_read_b64_tr_b16 v[16:17], v7 offset:18432
ds_read_b64_tr_b16 v[18:19], v7 offset:18944
s_waitcnt lgkmcnt(4)
v_mfma_f32_32x32x16_bf16 v[64:79], v[28:31], a[208:211], v[64:79]
v_mfma_f32_32x32x16_bf16 v[80:95], v[32:35], a[208:211], v[80:95]
s_waitcnt vmcnt(9)
v_mfma_f32_32x32x16_bf16 v[96:111], v[28:31], a[212:215], v[96:111]
ds_read_b64_tr_b16 v[20:21], v6 offset:20480
ds_read_b64_tr_b16 v[22:23], v6 offset:20992
v_mfma_f32_32x32x16_bf16 v[112:127], v[32:35], a[212:215], v[112:127]
ds_read_b64_tr_b16 v[24:25], v7 offset:20480
ds_read_b64_tr_b16 v[26:27], v7 offset:20992
s_waitcnt lgkmcnt(4)
v_mfma_f32_32x32x16_bf16 v[64:79], v[12:15], a[216:219], v[64:79]
v_mfma_f32_32x32x16_bf16 v[80:95], v[16:19], a[216:219], v[80:95]
s_waitcnt vmcnt(7)
v_mfma_f32_32x32x16_bf16 v[96:111], v[12:15], a[220:223], v[96:111]
ds_read_b64_tr_b16 v[28:29], v6 offset:22528
ds_read_b64_tr_b16 v[30:31], v6 offset:23040
v_mfma_f32_32x32x16_bf16 v[112:127], v[16:19], a[220:223], v[112:127]
ds_read_b64_tr_b16 v[32:33], v7 offset:22528
ds_read_b64_tr_b16 v[34:35], v7 offset:23040
s_waitcnt lgkmcnt(4)
v_mfma_f32_32x32x16_bf16 v[64:79], v[20:23], a[224:227], v[64:79]
v_mfma_f32_32x32x16_bf16 v[80:95], v[24:27], a[224:227], v[80:95]
s_waitcnt vmcnt(5)
v_mfma_f32_32x32x16_bf16 v[96:111], v[20:23], a[228:231], v[96:111]
ds_read_b64_tr_b16 v[12:13], v6 offset:24576
ds_read_b64_tr_b16 v[14:15], v6 offset:25088
v_mfma_f32_32x32x16_bf16 v[112:127], v[24:27], a[228:231], v[112:127]
ds_read_b64_tr_b16 v[16:17], v7 offset:24576
ds_read_b64_tr_b16 v[18:19], v7 offset:25088
s_waitcnt lgkmcnt(4)
v_mfma_f32_32x32x16_bf16 v[64:79], v[28:31], a[232:235], v[64:79]
v_mfma_f32_32x32x16_bf16 v[80:95], v[32:35], a[232:235], v[80:95]
s_waitcnt vmcnt(3)
v_mfma_f32_32x32x16_bf16 v[96:111], v[28:31], a[236:239], v[96:111]
ds_read_b64_tr_b16 v[20:21], v6 offset:26624
ds_read_b64_tr_b16 v[22:23], v6 offset:27136
v_mfma_f32_32x32x16_bf16 v[112:127], v[32:35], a[236:239], v[112:127]
ds_read_b64_tr_b16 v[24:25], v7 offset:26624
ds_read_b64_tr_b16 v[26:27], v7 offset:27136
s_waitcnt lgkmcnt(4)
v_mfma_f32_32x32x16_bf16 v[64:79], v[12:15], a[240:243], v[64:79]
v_mfma_f32_32x32x16_bf16 v[80:95], v[16:19], a[240:243], v[80:95]
v_mfma_f32_32x32x16_bf16 v[96:111], v[12:15], a[244:247], v[96:111]
v_mfma_f32_32x32x16_bf16 v[112:127], v[16:19], a[244:247], v[112:127]
s_waitcnt lgkmcnt(0)
v_mfma_f32_32x32x16_bf16 v[64:79], v[20:23], a[248:251], v[64:79]
v_mfma_f32_32x32x16_bf16 v[80:95], v[24:27], a[248:251], v[80:95]
v_mfma_f32_32x32x16_bf16 v[96:111], v[20:23], a[252:255], v[96:111]
v_mfma_f32_32x32x16_bf16 v[112:127], v[24:27], a[252:255], v[112:127]
s_add_u32 m0, s29, 28672
s_nop 0
buffer_load_dwordx4 v4, s[40:43], s53 offen  lds
buffer_load_dwordx4 v5, s[40:43], s53 offen offset:1024  lds
s_add_u32 s53, s53, 262144
s_cmp_ge_u32 s53, 7340032
s_cselect_b32 s93, 7340032, 0
s_sub_u32 s53, s53, s93
s_add_u32 m0, s29, 30720
s_nop 0
buffer_load_dwordx4 v4, s[40:43], s53 offen  lds
buffer_load_dwordx4 v5, s[40:43], s53 offen offset:1024  lds
s_add_u32 s53, s53, 262144
s_cmp_ge_u32 s53, 7340032
s_cselect_b32 s93, 7340032, 0
s_sub_u32 s53, s53, s93
s_add_u32 m0, s29, 32768
s_nop 0
buffer_load_dwordx4 v4, s[40:43], s53 offen  lds
buffer_load_dwordx4 v5, s[40:43], s53 offen offset:1024  lds
s_add_u32 s53, s53, 262144
s_cmp_ge_u32 s53, 7340032
s_cselect_b32 s93, 7340032, 0
s_sub_u32 s53, s53, s93
s_add_u32 m0, s29, 34816
s_nop 0
buffer_load_dwordx4 v4, s[40:43], s53 offen  lds
buffer_load_dwordx4 v5, s[40:43], s53 offen offset:1024  lds
s_add_u32 s53, s53, 262144
s_cmp_ge_u32 s53, 7340032
s_cselect_b32 s93, 7340032, 0
s_sub_u32 s53, s53, s93
v_lshlrev_b32 v44, 4, v1
v_add_u32 v45, s29, v44
s_xor_b32 s56, s3, 1
s_mul_i32 s56, s56, 36864
v_add_u32 v46, s56, v44
s_xor_b32 s56, s3, 2
s_mul_i32 s56, s56, 36864
v_add_u32 v47, s56, v44
s_xor_b32 s56, s3, 3
s_mul_i32 s56, s56, 36864
v_add_u32 v48, s56, v44
s_nop 7
ds_write_b128 v45, v[80:83] offset:0
ds_write_b128 v45, v[84:87] offset:1024
ds_write_b128 v45, v[88:91] offset:2048
ds_write_b128 v45, v[92:95] offset:3072
ds_write_b128 v45, v[96:99] offset:4096
ds_write_b128 v45, v[100:103] offset:5120
ds_write_b128 v45, v[104:107] offset:6144
ds_write_b128 v45, v[108:111] offset:7168
ds_write_b128 v45, v[112:115] offset:8192
ds_write_b128 v45, v[116:119] offset:9216
ds_write_b128 v45, v[120:123] offset:10240
ds_write_b128 v45, v[124:127] offset:11264
s_waitcnt lgkmcnt(0)
s_barrier
ds_read_b128 v[80:83], v46 offset:0
ds_read_b128 v[84:87], v46 offset:1024
ds_read_b128 v[88:91], v46 offset:2048
ds_read_b128 v[92:95], v46 offset:3072
ds_read_b128 v[96:99], v47 offset:4096
ds_read_b128 v[100:103], v47 offset:5120
ds_read_b128 v[104:107], v47 offset:6144
ds_read_b128 v[108:111], v47 offset:7168
ds_read_b128 v[112:115], v48 offset:8192
ds_read_b128 v[116:119], v48 offset:9216
ds_read_b128 v[120:123], v48 offset:10240
ds_read_b128 v[124:127], v48 offset:11264
s_waitcnt lgkmcnt(8)
v_add_f32 v128, v64, v80
v_add_f32 v129, v65, v81
v_add_f32 v130, v66, v82
v_add_f32 v131, v67, v83
v_add_f32 v132, v68, v84
v_add_f32 v133, v69, v85
v_add_f32 v134, v70, v86
v_add_f32 v135, v71, v87
v_add_f32 v136, v72, v88
v_add_f32 v137, v73, v89
v_add_f32 v138, v74, v90
v_add_f32 v139, v75, v91
v_add_f32 v140, v76, v92
v_add_f32 v141, v77, v93
v_add_f32 v142, v78, v94
v_add_f32 v143, v79, v95
s_waitcnt lgkmcnt(4)
v_add_f32 v128, v128, v96
v_add_f32 v129, v129, v97
v_add_f32 v130, v130, v98
v_add_f32 v131, v131, v99
v_add_f32 v132, v132, v100
v_add_f32 v133, v133, v101
v_add_f32 v134, v134, v102
v_add_f32 v135, v135, v103
v_add_f32 v136, v136, v104
v_add_f32 v137, v137, v105
v_add_f32 v138, v138, v106
v_add_f32 v139, v139, v107
v_add_f32 v140, v140, v108
v_add_f32 v141, v141, v109
v_add_f32 v142, v142, v110
v_add_f32 v143, v143, v111
s_waitcnt lgkmcnt(0)
v_add_f32 v128, v128, v112
v_add_f32 v129, v129, v113
v_add_f32 v130, v130, v114
v_add_f32 v131, v131, v115
v_add_f32 v132, v132, v116
v_add_f32 v133, v133, v117
v_add_f32 v134, v134, v118
v_add_f32 v135, v135, v119
v_add_f32 v136, v136, v120
v_add_f32 v137, v137, v121
v_add_f32 v138, v138, v122
v_add_f32 v139, v139, v123
v_add_f32 v140, v140, v124
v_add_f32 v141, v141, v125
v_add_f32 v142, v142, v126
v_add_f32 v143, v143, v127
v_lshlrev_b32 v60, 16, v60
s_mov_b32 s58, 0xc0135761
s_mov_b32 s59, 0xbdd2d3e8
v_mov_b32 v61, s58
v_cvt_pk_bf16_f32 v44, v128, v129
v_lshlrev_b32 v128, 16, v44
v_and_b32 v129, 0xffff0000, v44
v_add_f32 v128, v128, v60
v_add_f32 v129, v129, v60
v_cvt_pk_bf16_f32 v44, v128, v129
v_lshlrev_b32 v128, 16, v44
v_and_b32 v129, 0xffff0000, v44
v_mul_f32 v45, v128, v128
v_mul_f32 v46, v129, v129
v_fma_f32 v45, v45, s59, v61
v_fma_f32 v46, v46, s59, v61
v_mul_f32 v45, v45, v128
v_mul_f32 v46, v46, v129
v_exp_f32 v45, v45
v_exp_f32 v46, v46
s_nop 0
v_add_f32 v45, 1.0, v45
v_add_f32 v46, 1.0, v46
v_rcp_f32 v45, v45
v_rcp_f32 v46, v46
s_nop 0
v_mul_f32 v128, v128, v45
v_mul_f32 v129, v129, v46
v_cvt_pk_bf16_f32 v44, v130, v131
v_lshlrev_b32 v130, 16, v44
v_and_b32 v131, 0xffff0000, v44
v_add_f32 v130, v130, v60
v_add_f32 v131, v131, v60
v_cvt_pk_bf16_f32 v44, v130, v131
v_lshlrev_b32 v130, 16, v44
v_and_b32 v131, 0xffff0000, v44
v_mul_f32 v45, v130, v130
v_mul_f32 v46, v131, v131
v_fma_f32 v45, v45, s59, v61
v_fma_f32 v46, v46, s59, v61
v_mul_f32 v45, v45, v130
v_mul_f32 v46, v46, v131
v_exp_f32 v45, v45
v_exp_f32 v46, v46
s_nop 0
v_add_f32 v45, 1.0, v45
v_add_f32 v46, 1.0, v46
v_rcp_f32 v45, v45
v_rcp_f32 v46, v46
s_nop 0
v_mul_f32 v130, v130, v45
v_mul_f32 v131, v131, v46
v_cvt_pk_bf16_f32 v44, v132, v133
v_lshlrev_b32 v132, 16, v44
v_and_b32 v133, 0xffff0000, v44
v_add_f32 v132, v132, v60
v_add_f32 v133, v133, v60
v_cvt_pk_bf16_f32 v44, v132, v133
v_lshlrev_b32 v132, 16, v44
v_and_b32 v133, 0xffff0000, v44
v_mul_f32 v45, v132, v132
v_mul_f32 v46, v133, v133
v_fma_f32 v45, v45, s59, v61
v_fma_f32 v46, v46, s59, v61
v_mul_f32 v45, v45, v132
v_mul_f32 v46, v46, v133
v_exp_f32 v45, v45
v_exp_f32 v46, v46
s_nop 0
v_add_f32 v45, 1.0, v45
v_add_f32 v46, 1.0, v46
v_rcp_f32 v45, v45
v_rcp_f32 v46, v46
s_nop 0
v_mul_f32 v132, v132, v45
v_mul_f32 v133, v133, v46
v_cvt_pk_bf16_f32 v44, v134, v135
v_lshlrev_b32 v134, 16, v44
v_and_b32 v135, 0xffff0000, v44
v_add_f32 v134, v134, v60
v_add_f32 v135, v135, v60
v_cvt_pk_bf16_f32 v44, v134, v135
v_lshlrev_b32 v134, 16, v44
v_and_b32 v135, 0xffff0000, v44
v_mul_f32 v45, v134, v134
v_mul_f32 v46, v135, v135
v_fma_f32 v45, v45, s59, v61
v_fma_f32 v46, v46, s59, v61
v_mul_f32 v45, v45, v134
v_mul_f32 v46, v46, v135
v_exp_f32 v45, v45
v_exp_f32 v46, v46
s_nop 0
v_add_f32 v45, 1.0, v45
v_add_f32 v46, 1.0, v46
v_rcp_f32 v45, v45
v_rcp_f32 v46, v46
s_nop 0
v_mul_f32 v134, v134, v45
v_mul_f32 v135, v135, v46
v_cvt_pk_bf16_f32 v44, v136, v137
v_lshlrev_b32 v136, 16, v44
v_and_b32 v137, 0xffff0000, v44
v_add_f32 v136, v136, v60
v_add_f32 v137, v137, v60
v_cvt_pk_bf16_f32 v44, v136, v137
v_lshlrev_b32 v136, 16, v44
v_and_b32 v137, 0xffff0000, v44
v_mul_f32 v45, v136, v136
v_mul_f32 v46, v137, v137
v_fma_f32 v45, v45, s59, v61
v_fma_f32 v46, v46, s59, v61
v_mul_f32 v45, v45, v136
v_mul_f32 v46, v46, v137
v_exp_f32 v45, v45
v_exp_f32 v46, v46
s_nop 0
v_add_f32 v45, 1.0, v45
v_add_f32 v46, 1.0, v46
v_rcp_f32 v45, v45
v_rcp_f32 v46, v46
s_nop 0
v_mul_f32 v136, v136, v45
v_mul_f32 v137, v137, v46
v_cvt_pk_bf16_f32 v44, v138, v139
v_lshlrev_b32 v138, 16, v44
v_and_b32 v139, 0xffff0000, v44
v_add_f32 v138, v138, v60
v_add_f32 v139, v139, v60
v_cvt_pk_bf16_f32 v44, v138, v139
v_lshlrev_b32 v138, 16, v44
v_and_b32 v139, 0xffff0000, v44
v_mul_f32 v45, v138, v138
v_mul_f32 v46, v139, v139
v_fma_f32 v45, v45, s59, v61
v_fma_f32 v46, v46, s59, v61
v_mul_f32 v45, v45, v138
v_mul_f32 v46, v46, v139
v_exp_f32 v45, v45
v_exp_f32 v46, v46
s_nop 0
v_add_f32 v45, 1.0, v45
v_add_f32 v46, 1.0, v46
v_rcp_f32 v45, v45
v_rcp_f32 v46, v46
s_nop 0
v_mul_f32 v138, v138, v45
v_mul_f32 v139, v139, v46
v_cvt_pk_bf16_f32 v44, v140, v141
v_lshlrev_b32 v140, 16, v44
v_and_b32 v141, 0xffff0000, v44
v_add_f32 v140, v140, v60
v_add_f32 v141, v141, v60
v_cvt_pk_bf16_f32 v44, v140, v141
v_lshlrev_b32 v140, 16, v44
v_and_b32 v141, 0xffff0000, v44
v_mul_f32 v45, v140, v140
v_mul_f32 v46, v141, v141
v_fma_f32 v45, v45, s59, v61
v_fma_f32 v46, v46, s59, v61
v_mul_f32 v45, v45, v140
v_mul_f32 v46, v46, v141
v_exp_f32 v45, v45
v_exp_f32 v46, v46
s_nop 0
v_add_f32 v45, 1.0, v45
v_add_f32 v46, 1.0, v46
v_rcp_f32 v45, v45
v_rcp_f32 v46, v46
s_nop 0
v_mul_f32 v140, v140, v45
v_mul_f32 v141, v141, v46
v_cvt_pk_bf16_f32 v44, v142, v143
v_lshlrev_b32 v142, 16, v44
v_and_b32 v143, 0xffff0000, v44
v_add_f32 v142, v142, v60
v_add_f32 v143, v143, v60
v_cvt_pk_bf16_f32 v44, v142, v143
v_lshlrev_b32 v142, 16, v44
v_and_b32 v143, 0xffff0000, v44
v_mul_f32 v45, v142, v142
v_mul_f32 v46, v143, v143
v_fma_f32 v45, v45, s59, v61
v_fma_f32 v46, v46, s59, v61
v_mul_f32 v45, v45, v142
v_mul_f32 v46, v46, v143
v_exp_f32 v45, v45
v_exp_f32 v46, v46
s_nop 0
v_add_f32 v45, 1.0, v45
v_add_f32 v46, 1.0, v46
v_rcp_f32 v45, v45
v_rcp_f32 v46, v46
s_nop 0
v_mul_f32 v142, v142, v45
v_mul_f32 v143, v143, v46
s_nop 1
v_permlane32_swap_b32 v128, v132
v_permlane32_swap_b32 v129, v133
v_permlane32_swap_b32 v130, v134
v_permlane32_swap_b32 v131, v135
v_permlane32_swap_b32 v136, v140
v_permlane32_swap_b32 v137, v141
v_permlane32_swap_b32 v138, v142
v_permlane32_swap_b32 v139, v143
v_cvt_pk_bf16_f32 v52, v128, v129
v_cvt_pk_bf16_f32 v53, v130, v131
v_cvt_pk_bf16_f32 v54, v132, v133
v_cvt_pk_bf16_f32 v55, v134, v135
v_cvt_pk_bf16_f32 v56, v136, v137
v_cvt_pk_bf16_f32 v57, v138, v139
v_cvt_pk_bf16_f32 v58, v140, v141
v_cvt_pk_bf16_f32 v59, v142, v143
s_add_u32 s48, s24, 2097152
s_addc_u32 s49, s25, 0
s_mov_b32 s50, 1835008
s_mov_b32 s51, 0x20000
s_lshr_b32 s56, s3, 1
s_lshl_b32 s56, s56, 5
v_and_b32 v44, 31, v1
v_add_u32 v44, s56, v44
v_mul_u32_u24 v44, 144, v44
s_and_b32 s56, s3, 1
s_lshl_b32 s56, s56, 6
s_add_u32 s56, s56, 147456
v_lshrrev_b32 v45, 5, v1
v_lshl_add_u32 v44, v45, 4, v44
v_add_u32 v44, s56, v44
ds_write_b128 v44, v[52:55]
ds_write_b128 v44, v[56:59] offset:32
v_lshrrev_b32 v45, 3, v1
s_lshl_b32 s56, s3, 4
v_add_u32 v45, s56, v45
v_and_b32 v46, 7, v1
v_lshlrev_b32 v46, 4, v46
v_mul_u32_u24 v47, 144, v45
v_add_u32 v47, v47, v46
v_add_u32 v47, 147456, v47
s_lshl_b32 s60, s31, 16
s_lshl_b32 s61, s30, 7
s_add_u32 s60, s60, s61
v_lshl_add_u32 v45, v45, 10, v46
v_add_u32 v45, s60, v45
s_waitcnt lgkmcnt(0)
s_barrier
ds_read_b128 v[52:55], v47
ds_read_b128 v[56:59], v47 offset:1152
s_mov_b32 s56, 8192
s_waitcnt lgkmcnt(0)
buffer_store_dwordx4 v[52:55], v45, s[48:51], 0 offen sc1
buffer_store_dwordx4 v[56:59], v45, s[48:51], s56 offen sc1
s_add_u32 m0, s29, 12288
s_nop 0
buffer_load_dwordx4 v4, s[40:43], s53 offen  lds
buffer_load_dwordx4 v5, s[40:43], s53 offen offset:1024  lds
s_add_u32 s53, s53, 262144
s_cmp_ge_u32 s53, 7340032
s_cselect_b32 s93, 7340032, 0
s_sub_u32 s53, s53, s93
s_add_u32 m0, s29, 14336
s_nop 0
buffer_load_dwordx4 v4, s[40:43], s53 offen  lds
buffer_load_dwordx4 v5, s[40:43], s53 offen offset:1024  lds
s_add_u32 s53, s53, 262144
s_cmp_ge_u32 s53, 7340032
s_cselect_b32 s93, 7340032, 0
s_sub_u32 s53, s53, s93
s_add_u32 m0, s29, 16384
s_nop 0
buffer_load_dwordx4 v4, s[40:43], s53 offen  lds
buffer_load_dwordx4 v5, s[40:43], s53 offen offset:1024  lds
s_add_u32 s53, s53, 262144
s_cmp_ge_u32 s53, 7340032
s_cselect_b32 s93, 7340032, 0
s_sub_u32 s53, s53, s93
s_add_u32 m0, s29, 18432
s_nop 0
buffer_load_dwordx4 v4, s[40:43], s53 offen  lds
buffer_load_dwordx4 v5, s[40:43], s53 offen offset:1024  lds
s_add_u32 s53, s53, 262144
s_cmp_ge_u32 s53, 7340032
s_cselect_b32 s93, 7340032, 0
s_sub_u32 s53, s53, s93
s_add_u32 m0, s29, 20480
s_nop 0
buffer_load_dwordx4 v4, s[40:43], s53 offen  lds
buffer_load_dwordx4 v5, s[40:43], s53 offen offset:1024  lds
s_add_u32 s53, s53, 262144
s_cmp_ge_u32 s53, 7340032
s_cselect_b32 s93, 7340032, 0
s_sub_u32 s53, s53, s93
s_waitcnt vmcnt(10)
s_barrier
s_cmp_lg_u32 s3, 0
s_cbranch_scc1 L_pub_17
s_lshl_b32 s56, s30, 5
s_add_u32 s56, s56, s31
s_lshl_b32 s56, s56, 7
s_add_u32 s56, s56, 9011200
s_mov_b64 exec, 1
v_mov_b32 v44, s26
v_mov_b32 v45, s56
global_store_dword v45, v44, s[24:25] sc1
s_mov_b64 exec, -1
L_pub_17:
v_and_b32 v1, 63, v0
v_lshrrev_b32 v44, 5, v1
v_lshlrev_b32 v44, 3, v44
v_bfe_u32 v45, v1, 2, 2
v_add_u32 v44, v44, v45
v_lshlrev_b32 v44, 7, v44
v_bfe_u32 v46, v1, 4, 1
v_lshlrev_b32 v46, 5, v46
v_and_b32 v47, 3, v1
v_lshl_add_u32 v46, v47, 3, v46
v_lshlrev_b32 v45, 5, v45
v_and_b32 v45, 64, v45
v_or_b32 v46, v46, v45
v_add3_u32 v44, v44, v46, s29
s_lshl_b32 s56, s3, 6
s_and_b32 s56, s56, 64
v_xor_b32 v6, s56, v44
v_xor_b32 v7, 64, v6
s_lshl_b32 s56, s3, 5
s_and_b32 s56, s56, 64
v_xor_b32 v8, s56, v44
v_xor_b32 v9, 64, v8
s_add_u32 s36, s24, 2097152
s_addc_u32 s37, s25, 0
s_mov_b32 s38, 1835008
s_mov_b32 s39, 0x20000
s_lshl_b32 s57, s30, 7
v_lshrrev_b32 v44, 3, v1
v_and_b32 v45, 7, v1
v_lshlrev_b32 v46, 1, v44
v_and_b32 v46, 4, v46
v_xor_b32 v45, v45, v46
v_lshlrev_b32 v45, 4, v45
s_mov_b32 s56, 1024
v_mad_u32_u24 v2, v44, s56, v45
v_add_u32 v2, s57, v2
v_add_u32 v3, 7168, v2
s_mul_i32 s52, s3, 16384
s_lshl_b32 s56, s95, 16
s_add_u32 s52, s52, s56
s_add_u32 s44, s24, 9437184
s_addc_u32 s45, s25, 0
s_mov_b32 s46, 2097152
s_mov_b32 s47, 0x20000
s_lshl_b32 s57, s32, 7
v_lshrrev_b32 v44, 3, v1
v_and_b32 v45, 7, v1
v_lshlrev_b32 v46, 1, v44
v_and_b32 v46, 4, v46
v_xor_b32 v45, v45, v46
v_lshlrev_b32 v45, 4, v45
s_mov_b32 s56, 4096
v_mad_u32_u24 v4, v44, s56, v45
v_add_u32 v4, s57, v4
v_add_u32 v5, 31744, v4
s_mul_i32 s97, s3, 65536
s_lshl_b32 s56, s96, 18
s_add_u32 s97, s97, s56
s_lshr_b32 s56, s3, 1
s_lshl_b32 s56, s56, 5
s_lshl_b32 s57, s32, 6
s_add_u32 s56, s56, s57
v_and_b32 v44, 31, v1
v_add_u32 v44, s56, v44
s_and_b32 s56, s3, 1
s_lshl_b32 s56, s56, 6
s_lshl_b32 s57, s30, 7
s_add_u32 s56, s56, s57
v_lshrrev_b32 v45, 5, v1
v_lshlrev_b32 v45, 4, v45
v_lshl_add_u32 v50, v44, 10, v45
v_add_u32 v50, s56, v50
v_lshrrev_b32 v49, 9, v50
v_and_b32 v49, 0xfffffffe, v49
v_add_u32 v49, 9441280, v49
v_min_u32 v63, 31, v1
v_lshlrev_b32 v63, 7, v63
v_add_u32 v63, 9043968, v63
s_add_u32 m0, s29, 22528
s_nop 0
buffer_load_dwordx4 v4, s[40:43], s53 offen  lds
buffer_load_dwordx4 v5, s[40:43], s53 offen offset:1024  lds
s_add_u32 s53, s53, 262144
s_cmp_ge_u32 s53, 7340032
s_cselect_b32 s93, 7340032, 0
s_sub_u32 s53, s53, s93
s_add_u32 m0, s29, 24576
s_nop 0
buffer_load_dwordx4 v4, s[40:43], s53 offen  lds
buffer_load_dwordx4 v5, s[40:43], s53 offen offset:1024  lds
s_add_u32 s53, s53, 262144
s_cmp_ge_u32 s53, 7340032
s_cselect_b32 s93, 7340032, 0
s_sub_u32 s53, s53, s93
s_add_u32 m0, s29, 26624
s_nop 0
buffer_load_dwordx4 v4, s[40:43], s53 offen  lds
buffer_load_dwordx4 v5, s[40:43], s53 offen offset:1024  lds
s_add_u32 s53, s53, 262144
s_cmp_ge_u32 s53, 7340032
s_cselect_b32 s93, 7340032, 0
s_sub_u32 s53, s53, s93
s_add_u32 m0, s29, 0
s_nop 0
buffer_load_dwordx4 v4, s[40:43], s53 offen  lds
buffer_load_dwordx4 v5, s[40:43], s53 offen offset:1024  lds
s_add_u32 s53, s53, 262144
s_cmp_ge_u32 s53, 7340032
s_cselect_b32 s93, 7340032, 0
s_sub_u32 s53, s53, s93
s_add_u32 m0, s29, 2048
s_nop 0
buffer_load_dwordx4 v4, s[40:43], s53 offen  lds
buffer_load_dwordx4 v5, s[40:43], s53 offen offset:1024  lds
s_add_u32 s53, s53, 262144
s_cmp_ge_u32 s53, 7340032
s_cselect_b32 s93, 7340032, 0
s_sub_u32 s53, s53, s93
s_add_u32 m0, s29, 4096
s_nop 0
buffer_load_dwordx4 v4, s[40:43], s53 offen  lds
buffer_load_dwordx4 v5, s[40:43], s53 offen offset:1024  lds
s_add_u32 s53, s53, 262144
s_cmp_ge_u32 s53, 7340032
s_cselect_b32 s93, 7340032, 0
s_sub_u32 s53, s53, s93
s_add_u32 m0, s29, 6144
s_nop 0
buffer_load_dwordx4 v4, s[40:43], s53 offen  lds
buffer_load_dwordx4 v5, s[40:43], s53 offen offset:1024  lds
s_add_u32 s53, s53, 262144
s_cmp_ge_u32 s53, 7340032
s_cselect_b32 s93, 7340032, 0
s_sub_u32 s53, s53, s93
s_add_u32 m0, s29, 8192
s_nop 0
buffer_load_dwordx4 v4, s[40:43], s53 offen  lds
buffer_load_dwordx4 v5, s[40:43], s53 offen offset:1024  lds
s_add_u32 s53, s53, 262144
s_cmp_ge_u32 s53, 7340032
s_cselect_b32 s93, 7340032, 0
s_sub_u32 s53, s53, s93
s_add_u32 m0, s29, 10240
s_nop 0
buffer_load_dwordx4 v4, s[40:43], s53 offen  lds
buffer_load_dwordx4 v5, s[40:43], s53 offen offset:1024  lds
s_add_u32 s53, s53, 262144
s_cmp_ge_u32 s53, 7340032
s_cselect_b32 s93, 7340032, 0
s_sub_u32 s53, s53, s93
s_waitcnt vmcnt(36)
ds_read_b64_tr_b16 a[0:1], v8 offset:28672
ds_read_b64_tr_b16 a[2:3], v8 offset:29184
ds_read_b64_tr_b16 a[4:5], v9 offset:28672
ds_read_b64_tr_b16 a[6:7], v9 offset:29184
s_waitcnt vmcnt(34)
ds_read_b64_tr_b16 a[8:9], v8 offset:30720
ds_read_b64_tr_b16 a[10:11], v8 offset:31232
ds_read_b64_tr_b16 a[12:13], v9 offset:30720
ds_read_b64_tr_b16 a[14:15], v9 offset:31232
s_waitcnt lgkmcnt(4)
s_add_u32 m0, s29, 28672
s_nop 0
buffer_load_dwordx4 v4, s[40:43], s53 offen  lds
buffer_load_dwordx4 v5, s[40:43], s53 offen offset:1024  lds
s_add_u32 s53, s53, 262144
s_cmp_ge_u32 s53, 7340032
s_cselect_b32 s93, 7340032, 0
s_sub_u32 s53, s53, s93
s_waitcnt vmcnt(34)
ds_read_b64_tr_b16 a[16:17], v8 offset:32768
ds_read_b64_tr_b16 a[18:19], v8 offset:33280
ds_read_b64_tr_b16 a[20:21], v9 offset:32768
ds_read_b64_tr_b16 a[22:23], v9 offset:33280
s_waitcnt lgkmcnt(4)
s_add_u32 m0, s29, 30720
s_nop 0
buffer_load_dwordx4 v4, s[40:43], s53 offen  lds
buffer_load_dwordx4 v5, s[40:43], s53 offen offset:1024  lds
s_add_u32 s53, s53, 262144
s_cmp_ge_u32 s53, 7340032
s_cselect_b32 s93, 7340032, 0
s_sub_u32 s53, s53, s93
s_waitcnt vmcnt(34)
ds_read_b64_tr_b16 a[24:25], v8 offset:34816
ds_read_b64_tr_b16 a[26:27], v8 offset:35328
ds_read_b64_tr_b16 a[28:29], v9 offset:34816
ds_read_b64_tr_b16 a[30:31], v9 offset:35328
s_waitcnt lgkmcnt(4)
s_add_u32 m0, s29, 32768
s_nop 0
buffer_load_dwordx4 v4, s[40:43], s53 offen  lds
buffer_load_dwordx4 v5, s[40:43], s53 offen offset:1024  lds
s_add_u32 s53, s53, 262144
s_cmp_ge_u32 s53, 7340032
s_cselect_b32 s93, 7340032, 0
s_sub_u32 s53, s53, s93
s_waitcnt vmcnt(32)
ds_read_b64_tr_b16 a[32:33], v8 offset:12288
ds_read_b64_tr_b16 a[34:35], v8 offset:12800
ds_read_b64_tr_b16 a[36:37], v9 offset:12288
ds_read_b64_tr_b16 a[38:39], v9 offset:12800
s_waitcnt lgkmcnt(4)
s_add_u32 m0, s29, 34816
s_nop 0
buffer_load_dwordx4 v4, s[40:43], s53 offen  lds
buffer_load_dwordx4 v5, s[40:43], s53 offen offset:1024  lds
s_add_u32 s53, s53, 262144
s_cmp_ge_u32 s53, 7340032
s_cselect_b32 s93, 7340032, 0
s_sub_u32 s53, s53, s93
s_waitcnt vmcnt(32)
ds_read_b64_tr_b16 a[40:41], v8 offset:14336
ds_read_b64_tr_b16 a[42:43], v8 offset:14848
ds_read_b64_tr_b16 a[44:45], v9 offset:14336
ds_read_b64_tr_b16 a[46:47], v9 offset:14848
s_waitcnt lgkmcnt(4)
s_add_u32 m0, s29, 12288
s_nop 0
buffer_load_dwordx4 v4, s[40:43], s53 offen  lds
buffer_load_dwordx4 v5, s[40:43], s53 offen offset:1024  lds
s_add_u32 s53, s53, 262144
s_cmp_ge_u32 s53, 7340032
s_cselect_b32 s93, 7340032, 0
s_sub_u32 s53, s53, s93
s_waitcnt vmcnt(32)
ds_read_b64_tr_b16 a[48:49], v8 offset:16384
ds_read_b64_tr_b16 a[50:51], v8 offset:16896
ds_read_b64_tr_b16 a[52:53], v9 offset:16384
ds_read_b64_tr_b16 a[54:55], v9 offset:16896
s_waitcnt lgkmcnt(4)
s_add_u32 m0, s29, 14336
s_nop 0
buffer_load_dwordx4 v4, s[40:43], s53 offen  lds
buffer_load_dwordx4 v5, s[40:43], s53 offen offset:1024  lds
s_add_u32 s53, s53, 262144
s_cmp_ge_u32 s53, 7340032
s_cselect_b32 s93, 7340032, 0
s_sub_u32 s53, s53, s93
s_waitcnt vmcnt(32)
ds_read_b64_tr_b16 a[56:57], v8 offset:18432
ds_read_b64_tr_b16 a[58:59], v8 offset:18944
ds_read_b64_tr_b16 a[60:61], v9 offset:18432
ds_read_b64_tr_b16 a[62:63], v9 offset:18944
s_waitcnt lgkmcnt(4)
s_add_u32 m0, s29, 16384
s_nop 0
buffer_load_dwordx4 v4, s[40:43], s53 offen  lds
buffer_load_dwordx4 v5, s[40:43], s53 offen offset:1024  lds
s_add_u32 s53, s53, 262144
s_cmp_ge_u32 s53, 7340032
s_cselect_b32 s93, 7340032, 0
s_sub_u32 s53, s53, s93
s_waitcnt vmcnt(32)
ds_read_b64_tr_b16 a[64:65], v8 offset:20480
ds_read_b64_tr_b16 a[66:67], v8 offset:20992
ds_read_b64_tr_b16 a[68:69], v9 offset:20480
ds_read_b64_tr_b16 a[70:71], v9 offset:20992
s_waitcnt lgkmcnt(4)
s_add_u32 m0, s29, 18432
s_nop 0
buffer_load_dwordx4 v4, s[40:43], s53 offen  lds
buffer_load_dwordx4 v5, s[40:43], s53 offen offset:1024  lds
s_add_u32 s53, s53, 262144
s_cmp_ge_u32 s53, 7340032
s_cselect_b32 s93, 7340032, 0
s_sub_u32 s53, s53, s93
s_waitcnt vmcnt(32)
ds_read_b64_tr_b16 a[72:73], v8 offset:22528
ds_read_b64_tr_b16 a[74:75], v8 offset:23040
ds_read_b64_tr_b16 a[76:77], v9 offset:22528
ds_read_b64_tr_b16 a[78:79], v9 offset:23040
s_waitcnt lgkmcnt(4)
s_add_u32 m0, s29, 20480
s_nop 0
buffer_load_dwordx4 v4, s[40:43], s53 offen  lds
buffer_load_dwordx4 v5, s[40:43], s53 offen offset:1024  lds
s_add_u32 s53, s53, 262144
s_cmp_ge_u32 s53, 7340032
s_cselect_b32 s93, 7340032, 0
s_sub_u32 s53, s53, s93
s_waitcnt vmcnt(32)
ds_read_b64_tr_b16 a[80:81], v8 offset:24576
ds_read_b64_tr_b16 a[82:83], v8 offset:25088
ds_read_b64_tr_b16 a[84:85], v9 offset:24576
ds_read_b64_tr_b16 a[86:87], v9 offset:25088
s_waitcnt lgkmcnt(4)
s_add_u32 m0, s29, 22528
s_nop 0
buffer_load_dwordx4 v4, s[40:43], s53 offen  lds
buffer_load_dwordx4 v5, s[40:43], s53 offen offset:1024  lds
s_add_u32 s53, s53, 262144
s_cmp_ge_u32 s53, 7340032
s_cselect_b32 s93, 7340032, 0
s_sub_u32 s53, s53, s93
s_waitcnt vmcnt(32)
ds_read_b64_tr_b16 a[88:89], v8 offset:26624
ds_read_b64_tr_b16 a[90:91], v8 offset:27136
ds_read_b64_tr_b16 a[92:93], v9 offset:26624
ds_read_b64_tr_b16 a[94:95], v9 offset:27136
s_waitcnt lgkmcnt(4)
s_waitcnt vmcnt(30)
ds_read_b64_tr_b16 a[96:97], v8 offset:0
ds_read_b64_tr_b16 a[98:99], v8 offset:512
ds_read_b64_tr_b16 a[100:101], v9 offset:0
ds_read_b64_tr_b16 a[102:103], v9 offset:512
s_waitcnt lgkmcnt(4)
s_waitcnt vmcnt(28)
ds_read_b64_tr_b16 a[104:105], v8 offset:2048
ds_read_b64_tr_b16 a[106:107], v8 offset:2560
ds_read_b64_tr_b16 a[108:109], v9 offset:2048
ds_read_b64_tr_b16 a[110:111], v9 offset:2560
s_waitcnt lgkmcnt(4)
s_waitcnt vmcnt(26)
ds_read_b64_tr_b16 a[112:113], v8 offset:4096
ds_read_b64_tr_b16 a[114:115], v8 offset:4608
ds_read_b64_tr_b16 a[116:117], v9 offset:4096
ds_read_b64_tr_b16 a[118:119], v9 offset:4608
s_waitcnt lgkmcnt(4)
s_waitcnt vmcnt(24)
ds_read_b64_tr_b16 a[120:121], v8 offset:6144
ds_read_b64_tr_b16 a[122:123], v8 offset:6656
ds_read_b64_tr_b16 a[124:125], v9 offset:6144
ds_read_b64_tr_b16 a[126:127], v9 offset:6656
s_waitcnt lgkmcnt(4)
s_waitcnt vmcnt(22)
ds_read_b64_tr_b16 a[128:129], v8 offset:8192
ds_read_b64_tr_b16 a[130:131], v8 offset:8704
ds_read_b64_tr_b16 a[132:133], v9 offset:8192
ds_read_b64_tr_b16 a[134:135], v9 offset:8704
s_waitcnt lgkmcnt(4)
s_waitcnt vmcnt(20)
ds_read_b64_tr_b16 a[136:137], v8 offset:10240
ds_read_b64_tr_b16 a[138:139], v8 offset:10752
ds_read_b64_tr_b16 a[140:141], v9 offset:10240
ds_read_b64_tr_b16 a[142:143], v9 offset:10752
s_waitcnt lgkmcnt(4)
s_waitcnt vmcnt(18)
ds_read_b64_tr_b16 a[144:145], v8 offset:28672
ds_read_b64_tr_b16 a[146:147], v8 offset:29184
ds_read_b64_tr_b16 a[148:149], v9 offset:28672
ds_read_b64_tr_b16 a[150:151], v9 offset:29184
s_waitcnt lgkmcnt(4)
s_waitcnt vmcnt(16)
ds_read_b64_tr_b16 a[152:153], v8 offset:30720
ds_read_b64_tr_b16 a[154:155], v8 offset:31232
ds_read_b64_tr_b16 a[156:157], v9 offset:30720
ds_read_b64_tr_b16 a[158:159], v9 offset:31232
s_waitcnt lgkmcnt(4)
s_waitcnt vmcnt(14)
ds_read_b64_tr_b16 a[160:161], v8 offset:32768
ds_read_b64_tr_b16 a[162:163], v8 offset:33280
ds_read_b64_tr_b16 a[164:165], v9 offset:32768
ds_read_b64_tr_b16 a[166:167], v9 offset:33280
s_waitcnt lgkmcnt(4)
s_waitcnt vmcnt(12)
ds_read_b64_tr_b16 a[168:169], v8 offset:34816
ds_read_b64_tr_b16 a[170:171], v8 offset:35328
ds_read_b64_tr_b16 a[172:173], v9 offset:34816
ds_read_b64_tr_b16 a[174:175], v9 offset:35328
s_waitcnt lgkmcnt(4)
s_waitcnt vmcnt(10)
ds_read_b64_tr_b16 a[176:177], v8 offset:12288
ds_read_b64_tr_b16 a[178:179], v8 offset:12800
ds_read_b64_tr_b16 a[180:181], v9 offset:12288
ds_read_b64_tr_b16 a[182:183], v9 offset:12800
s_waitcnt lgkmcnt(4)
s_waitcnt vmcnt(8)
ds_read_b64_tr_b16 a[184:185], v8 offset:14336
ds_read_b64_tr_b16 a[186:187], v8 offset:14848
ds_read_b64_tr_b16 a[188:189], v9 offset:14336
ds_read_b64_tr_b16 a[190:191], v9 offset:14848
s_waitcnt lgkmcnt(4)
s_waitcnt vmcnt(6)
ds_read_b64_tr_b16 a[192:193], v8 offset:16384
ds_read_b64_tr_b16 a[194:195], v8 offset:16896
ds_read_b64_tr_b16 a[196:197], v9 offset:16384
ds_read_b64_tr_b16 a[198:199], v9 offset:16896
s_waitcnt lgkmcnt(4)
s_waitcnt vmcnt(4)
ds_read_b64_tr_b16 a[200:201], v8 offset:18432
ds_read_b64_tr_b16 a[202:203], v8 offset:18944
ds_read_b64_tr_b16 a[204:205], v9 offset:18432
ds_read_b64_tr_b16 a[206:207], v9 offset:18944
s_waitcnt lgkmcnt(4)
s_waitcnt vmcnt(2)
ds_read_b64_tr_b16 a[208:209], v8 offset:20480
ds_read_b64_tr_b16 a[210:211], v8 offset:20992
ds_read_b64_tr_b16 a[212:213], v9 offset:20480
ds_read_b64_tr_b16 a[214:215], v9 offset:20992
s_waitcnt lgkmcnt(4)
s_waitcnt vmcnt(0)
ds_read_b64_tr_b16 a[216:217], v8 offset:22528
ds_read_b64_tr_b16 a[218:219], v8 offset:23040
ds_read_b64_tr_b16 a[220:221], v9 offset:22528
ds_read_b64_tr_b16 a[222:223], v9 offset:23040
s_waitcnt lgkmcnt(4)
s_waitcnt lgkmcnt(0)
s_branch L_p3_3
L_fft_2:
s_waitcnt vmcnt(0)
s_add_u32 s36, s24, 4718592
s_addc_u32 s37, s25, 0
s_mov_b32 s38, 2097152
s_mov_b32 s39, 0x20000
s_add_u32 s40, s24, 6815744
s_addc_u32 s41, s25, 0
s_mov_b32 s42, 2097152
s_mov_b32 s43, 0x20000
s_add_u32 s44, s24, 9437184
s_addc_u32 s45, s25, 0
s_mov_b32 s46, 2097152
s_mov_b32 s47, 0x20000
v_lshrrev_b32 v8, 3, v1
v_and_b32 v9, 7, v1
v_xor_b32 v10, v9, v8
v_lshrrev_b32 v11, 1, v8
v_xor_b32 v11, v9, v11
v_lshlrev_b32 v8, 7, v8
s_lshr_b32 s56, s3, 1
s_lshl_b32 s56, s56, 5
s_add_u32 s56, s56, s33
s_lshl_b32 s56, s56, 15
s_and_b32 s57, s3, 1
s_lshl_b32 s57, s57, 14
s_add_u32 s56, s56, s57
s_lshl_b32 s58, s3, 14
v_mov_b32 v240, v8
v_mov_b32 v242, v10
v_mov_b32 v243, v11
s_lshl_b32 s60, s33, 16
s_add_u32 s60, s60, s58
v_xor_b32 v244, 0, v242
v_lshl_add_u32 v244, v244, 4, v240
s_add_u32 m0, s58, 0
s_add_u32 s59, s56, 0
buffer_load_dwordx4 v244, s[36:39], s59 offen  lds
v_xor_b32 v244, 1, v242
v_lshl_add_u32 v244, v244, 4, v240
s_add_u32 m0, s58, 1024
s_add_u32 s59, s56, 1024
buffer_load_dwordx4 v244, s[36:39], s59 offen  lds
v_xor_b32 v244, 2, v242
v_lshl_add_u32 v244, v244, 4, v240
s_add_u32 m0, s58, 2048
s_add_u32 s59, s56, 2048
buffer_load_dwordx4 v244, s[36:39], s59 offen  lds
v_xor_b32 v244, 3, v242
v_lshl_add_u32 v244, v244, 4, v240
s_add_u32 m0, s58, 3072
s_add_u32 s59, s56, 3072
buffer_load_dwordx4 v244, s[36:39], s59 offen  lds
v_xor_b32 v244, 4, v242
v_lshl_add_u32 v244, v244, 4, v240
s_add_u32 m0, s58, 4096
s_add_u32 s59, s56, 4096
buffer_load_dwordx4 v244, s[36:39], s59 offen  lds
v_xor_b32 v244, 5, v242
v_lshl_add_u32 v244, v244, 4, v240
s_add_u32 m0, s58, 5120
s_add_u32 s59, s56, 5120
buffer_load_dwordx4 v244, s[36:39], s59 offen  lds
v_and_b32 v10, 31, v1
v_cvt_f32_u32 v8, v10
v_lshrrev_b32 v10, 5, v1
v_cvt_f32_u32 v9, v10
v_mul_f32 v10, 0x3d000000, v8
v_mul_f32 v11, v8, v9
v_mul_f32 v11, 0x3e000000, v11
v_fmamk_f32 v12, v10, 0x00000000, v11
v_fmamk_f32 v13, v10, 0x3f800000, v11
v_sin_f32 v14, v12
v_sin_f32 v15, v13
v_cos_f32 v12, v12
v_cos_f32 v13, v13
v_cvt_pk_bf16_f32 v32, v14, v15
v_cvt_pk_bf16_f32 v40, -v14, -v15
v_cvt_pk_bf16_f32 v24, v12, v13
v_fmamk_f32 v12, v10, 0x40000000, v11
v_fmamk_f32 v13, v10, 0x40400000, v11
v_sin_f32 v14, v12
v_sin_f32 v15, v13
v_cos_f32 v12, v12
v_cos_f32 v13, v13
v_cvt_pk_bf16_f32 v33, v14, v15
v_cvt_pk_bf16_f32 v41, -v14, -v15
v_cvt_pk_bf16_f32 v25, v12, v13
v_fmamk_f32 v12, v10, 0x41000000, v11
v_fmamk_f32 v13, v10, 0x41100000, v11
v_sin_f32 v14, v12
v_sin_f32 v15, v13
v_cos_f32 v12, v12
v_cos_f32 v13, v13
v_cvt_pk_bf16_f32 v34, v14, v15
v_cvt_pk_bf16_f32 v42, -v14, -v15
v_cvt_pk_bf16_f32 v26, v12, v13
v_fmamk_f32 v12, v10, 0x41200000, v11
v_fmamk_f32 v13, v10, 0x41300000, v11
v_sin_f32 v14, v12
v_sin_f32 v15, v13
v_cos_f32 v12, v12
v_cos_f32 v13, v13
v_cvt_pk_bf16_f32 v35, v14, v15
v_cvt_pk_bf16_f32 v43, -v14, -v15
v_cvt_pk_bf16_f32 v27, v12, v13
v_fmamk_f32 v12, v10, 0x41800000, v11
v_fmamk_f32 v13, v10, 0x41880000, v11
v_sin_f32 v14, v12
v_sin_f32 v15, v13
v_cos_f32 v12, v12
v_cos_f32 v13, v13
v_cvt_pk_bf16_f32 v36, v14, v15
v_cvt_pk_bf16_f32 v44, -v14, -v15
v_cvt_pk_bf16_f32 v28, v12, v13
v_fmamk_f32 v12, v10, 0x41900000, v11
v_fmamk_f32 v13, v10, 0x41980000, v11
v_sin_f32 v14, v12
v_sin_f32 v15, v13
v_cos_f32 v12, v12
v_cos_f32 v13, v13
v_cvt_pk_bf16_f32 v37, v14, v15
v_cvt_pk_bf16_f32 v45, -v14, -v15
v_cvt_pk_bf16_f32 v29, v12, v13
v_fmamk_f32 v12, v10, 0x41c00000, v11
v_fmamk_f32 v13, v10, 0x41c80000, v11
v_sin_f32 v14, v12
v_sin_f32 v15, v13
v_cos_f32 v12, v12
v_cos_f32 v13, v13
v_cvt_pk_bf16_f32 v38, v14, v15
v_cvt_pk_bf16_f32 v46, -v14, -v15
v_cvt_pk_bf16_f32 v30, v12, v13
v_fmamk_f32 v12, v10, 0x41d00000, v11
v_fmamk_f32 v13, v10, 0x41d80000, v11
v_sin_f32 v14, v12
v_sin_f32 v15, v13
v_cos_f32 v12, v12
v_cos_f32 v13, v13
v_cvt_pk_bf16_f32 v39, v14, v15
v_cvt_pk_bf16_f32 v47, -v14, -v15
v_cvt_pk_bf16_f32 v31, v12, v13
v_mul_f32 v10, 0x3a800000, v8
v_mul_f32 v11, v8, v9
v_mul_f32 v11, 0x3b800000, v11
v_fmamk_f32 v48, v10, 0x00000000, v11
v_sin_f32 v64, v48
v_cos_f32 v48, v48
v_fmamk_f32 v49, v10, 0x3f800000, v11
v_sin_f32 v65, v49
v_cos_f32 v49, v49
v_fmamk_f32 v50, v10, 0x40000000, v11
v_sin_f32 v66, v50
v_cos_f32 v50, v50
v_fmamk_f32 v51, v10, 0x40400000, v11
v_sin_f32 v67, v51
v_cos_f32 v51, v51
v_fmamk_f32 v52, v10, 0x41000000, v11
v_sin_f32 v68, v52
v_cos_f32 v52, v52
v_fmamk_f32 v53, v10, 0x41100000, v11
v_sin_f32 v69, v53
v_cos_f32 v53, v53
v_fmamk_f32 v54, v10, 0x41200000, v11
v_sin_f32 v70, v54
v_cos_f32 v54, v54
v_fmamk_f32 v55, v10, 0x41300000, v11
v_sin_f32 v71, v55
v_cos_f32 v55, v55
v_fmamk_f32 v56, v10, 0x41800000, v11
v_sin_f32 v72, v56
v_cos_f32 v56, v56
v_fmamk_f32 v57, v10, 0x41880000, v11
v_sin_f32 v73, v57
v_cos_f32 v57, v57
v_fmamk_f32 v58, v10, 0x41900000, v11
v_sin_f32 v74, v58
v_cos_f32 v58, v58
v_fmamk_f32 v59, v10, 0x41980000, v11
v_sin_f32 v75, v59
v_cos_f32 v59, v59
v_fmamk_f32 v60, v10, 0x41c00000, v11
v_sin_f32 v76, v60
v_cos_f32 v60, v60
v_fmamk_f32 v61, v10, 0x41c80000, v11
v_sin_f32 v77, v61
v_cos_f32 v61, v61
v_fmamk_f32 v62, v10, 0x41d00000, v11
v_sin_f32 v78, v62
v_cos_f32 v62, v62
v_fmamk_f32 v63, v10, 0x41d80000, v11
v_sin_f32 v79, v63
v_cos_f32 v63, v63
v_mul_f32 v48, 0x3ab504f3, v48
v_mul_f32 v49, 0x3ab504f3, v49
v_mul_f32 v50, 0x3ab504f3, v50
v_mul_f32 v51, 0x3ab504f3, v51
v_mul_f32 v52, 0x3ab504f3, v52
v_mul_f32 v53, 0x3ab504f3, v53
v_mul_f32 v54, 0x3ab504f3, v54
v_mul_f32 v55, 0x3ab504f3, v55
v_mul_f32 v56, 0x3ab504f3, v56
v_mul_f32 v57, 0x3ab504f3, v57
v_mul_f32 v58, 0x3ab504f3, v58
v_mul_f32 v59, 0x3ab504f3, v59
v_mul_f32 v60, 0x3ab504f3, v60
v_mul_f32 v61, 0x3ab504f3, v61
v_mul_f32 v62, 0x3ab504f3, v62
v_mul_f32 v63, 0x3ab504f3, v63
v_mul_f32 v64, 0x3ab504f3, v64
v_mul_f32 v65, 0x3ab504f3, v65
v_mul_f32 v66, 0x3ab504f3, v66
v_mul_f32 v67, 0x3ab504f3, v67
v_mul_f32 v68, 0x3ab504f3, v68
v_mul_f32 v69, 0x3ab504f3, v69
v_mul_f32 v70, 0x3ab504f3, v70
v_mul_f32 v71, 0x3ab504f3, v71
v_mul_f32 v72, 0x3ab504f3, v72
v_mul_f32 v73, 0x3ab504f3, v73
v_mul_f32 v74, 0x3ab504f3, v74
v_mul_f32 v75, 0x3ab504f3, v75
v_mul_f32 v76, 0x3ab504f3, v76
v_mul_f32 v77, 0x3ab504f3, v77
v_mul_f32 v78, 0x3ab504f3, v78
v_mul_f32 v79, 0x3ab504f3, v79
v_mul_f32 v10, 0x3c800000, v8
v_fmamk_f32 v10, v9, 0x3b000000, v10
v_add_f32 v80, 0x00000000, v10
v_sin_f32 v96, v80
v_cos_f32 v80, v80
v_add_f32 v81, 0x3a000000, v10
v_sin_f32 v97, v81
v_cos_f32 v81, v81
v_add_f32 v82, 0x3a800000, v10
v_sin_f32 v98, v82
v_cos_f32 v82, v82
v_add_f32 v83, 0x3ac00000, v10
v_sin_f32 v99, v83
v_cos_f32 v83, v83
v_add_f32 v84, 0x3b800000, v10
v_sin_f32 v100, v84
v_cos_f32 v84, v84
v_add_f32 v85, 0x3b900000, v10
v_sin_f32 v101, v85
v_cos_f32 v85, v85
v_add_f32 v86, 0x3ba00000, v10
v_sin_f32 v102, v86
v_cos_f32 v86, v86
v_add_f32 v87, 0x3bb00000, v10
v_sin_f32 v103, v87
v_cos_f32 v87, v87
v_add_f32 v88, 0x3c000000, v10
v_sin_f32 v104, v88
v_cos_f32 v88, v88
v_add_f32 v89, 0x3c080000, v10
v_sin_f32 v105, v89
v_cos_f32 v89, v89
v_add_f32 v90, 0x3c100000, v10
v_sin_f32 v106, v90
v_cos_f32 v90, v90
v_add_f32 v91, 0x3c180000, v10
v_sin_f32 v107, v91
v_cos_f32 v91, v91
v_add_f32 v92, 0x3c400000, v10
v_sin_f32 v108, v92
v_cos_f32 v92, v92
v_add_f32 v93, 0x3c480000, v10
v_sin_f32 v109, v93
v_cos_f32 v93, v93
v_add_f32 v94, 0x3c500000, v10
v_sin_f32 v110, v94
v_cos_f32 v94, v94
v_add_f32 v95, 0x3c580000, v10
v_sin_f32 v111, v95
v_cos_f32 v95, v95
v_xor_b32 v244, 6, v242
v_lshl_add_u32 v244, v244, 4, v240
s_add_u32 m0, s58, 6144
s_add_u32 s59, s56, 6144
buffer_load_dwordx4 v244, s[36:39], s59 offen  lds
v_xor_b32 v244, 7, v242
v_lshl_add_u32 v244, v244, 4, v240
s_add_u32 m0, s58, 7168
s_add_u32 s59, s56, 7168
buffer_load_dwordx4 v244, s[36:39], s59 offen  lds
v_xor_b32 v244, 0, v242
v_lshl_add_u32 v244, v244, 4, v240
s_add_u32 m0, s58, 8192
s_add_u32 s59, s56, 8192
buffer_load_dwordx4 v244, s[36:39], s59 offen  lds
v_xor_b32 v244, 1, v242
v_lshl_add_u32 v244, v244, 4, v240
s_add_u32 m0, s58, 9216
s_add_u32 s59, s56, 9216
buffer_load_dwordx4 v244, s[36:39], s59 offen  lds
v_xor_b32 v244, 2, v242
v_lshl_add_u32 v244, v244, 4, v240
s_add_u32 m0, s58, 10240
s_add_u32 s59, s56, 10240
buffer_load_dwordx4 v244, s[36:39], s59 offen  lds
v_xor_b32 v244, 3, v242
v_lshl_add_u32 v244, v244, 4, v240
s_add_u32 m0, s58, 11264
s_add_u32 s59, s56, 11264
buffer_load_dwordx4 v244, s[36:39], s59 offen  lds
v_xor_b32 v244, 4, v242
v_lshl_add_u32 v244, v244, 4, v240
s_add_u32 m0, s58, 12288
s_add_u32 s59, s56, 12288
buffer_load_dwordx4 v244, s[36:39], s59 offen  lds
v_xor_b32 v244, 5, v242
v_lshl_add_u32 v244, v244, 4, v240
s_add_u32 m0, s58, 13312
s_add_u32 s59, s56, 13312
buffer_load_dwordx4 v244, s[36:39], s59 offen  lds
v_xor_b32 v244, 6, v242
v_lshl_add_u32 v244, v244, 4, v240
s_add_u32 m0, s58, 14336
s_add_u32 s59, s56, 14336
buffer_load_dwordx4 v244, s[36:39], s59 offen  lds
v_xor_b32 v244, 7, v242
v_lshl_add_u32 v244, v244, 4, v240
s_add_u32 m0, s58, 15360
s_add_u32 s59, s56, 15360
buffer_load_dwordx4 v244, s[36:39], s59 offen  lds
v_xor_b32 v244, 0, v243
v_lshl_add_u32 v244, v244, 4, v240
s_add_u32 m0, s58, 65536
s_add_u32 s59, s60, 0
buffer_load_dwordx4 v244, s[40:43], s59 offen  lds
v_xor_b32 v244, 4, v243
v_lshl_add_u32 v244, v244, 4, v240
s_add_u32 m0, s58, 66560
s_add_u32 s59, s60, 1024
buffer_load_dwordx4 v244, s[40:43], s59 offen  lds
v_xor_b32 v244, 0, v243
v_lshl_add_u32 v244, v244, 4, v240
s_add_u32 m0, s58, 67584
s_add_u32 s59, s60, 2048
buffer_load_dwordx4 v244, s[40:43], s59 offen  lds
v_xor_b32 v244, 4, v243
v_lshl_add_u32 v244, v244, 4, v240
s_add_u32 m0, s58, 68608
s_add_u32 s59, s60, 3072
buffer_load_dwordx4 v244, s[40:43], s59 offen  lds
v_xor_b32 v244, 0, v243
v_lshl_add_u32 v244, v244, 4, v240
s_add_u32 m0, s58, 69632
s_add_u32 s59, s60, 4096
buffer_load_dwordx4 v244, s[40:43], s59 offen  lds
v_xor_b32 v244, 4, v243
v_lshl_add_u32 v244, v244, 4, v240
s_add_u32 m0, s58, 70656
s_add_u32 s59, s60, 5120
buffer_load_dwordx4 v244, s[40:43], s59 offen  lds
v_xor_b32 v244, 0, v243
v_lshl_add_u32 v244, v244, 4, v240
s_add_u32 m0, s58, 71680
s_add_u32 s59, s60, 6144
buffer_load_dwordx4 v244, s[40:43], s59 offen  lds
v_xor_b32 v244, 4, v243
v_lshl_add_u32 v244, v244, 4, v240
s_add_u32 m0, s58, 72704
s_add_u32 s59, s60, 7168
buffer_load_dwordx4 v244, s[40:43], s59 offen  lds
v_xor_b32 v244, 0, v243
v_lshl_add_u32 v244, v244, 4, v240
s_add_u32 m0, s58, 73728
s_add_u32 s59, s60, 8192
buffer_load_dwordx4 v244, s[40:43], s59 offen  lds
v_xor_b32 v244, 4, v243
v_lshl_add_u32 v244, v244, 4, v240
s_add_u32 m0, s58, 74752
s_add_u32 s59, s60, 9216
buffer_load_dwordx4 v244, s[40:43], s59 offen  lds
v_xor_b32 v244, 0, v243
v_lshl_add_u32 v244, v244, 4, v240
s_add_u32 m0, s58, 75776
s_add_u32 s59, s60, 10240
buffer_load_dwordx4 v244, s[40:43], s59 offen  lds
v_xor_b32 v244, 4, v243
v_lshl_add_u32 v244, v244, 4, v240
s_add_u32 m0, s58, 76800
s_add_u32 s59, s60, 11264
buffer_load_dwordx4 v244, s[40:43], s59 offen  lds
v_xor_b32 v244, 0, v243
v_lshl_add_u32 v244, v244, 4, v240
s_add_u32 m0, s58, 77824
s_add_u32 s59, s60, 12288
buffer_load_dwordx4 v244, s[40:43], s59 offen  lds
v_xor_b32 v244, 4, v243
v_lshl_add_u32 v244, v244, 4, v240
s_add_u32 m0, s58, 78848
s_add_u32 s59, s60, 13312
buffer_load_dwordx4 v244, s[40:43], s59 offen  lds
v_xor_b32 v244, 0, v243
v_lshl_add_u32 v244, v244, 4, v240
s_add_u32 m0, s58, 79872
s_add_u32 s59, s60, 14336
buffer_load_dwordx4 v244, s[40:43], s59 offen  lds
v_xor_b32 v244, 4, v243
v_lshl_add_u32 v244, v244, 4, v240
s_add_u32 m0, s58, 80896
s_add_u32 s59, s60, 15360
buffer_load_dwordx4 v244, s[40:43], s59 offen  lds
v_lshrrev_b32 v8, 5, v1
v_bfe_u32 v9, v1, 2, 2
v_lshl_add_u32 v8, v8, 2, v9
v_bfe_u32 v9, v1, 4, 1
v_and_b32 v10, 3, v1
v_lshl_add_u32 v9, v9, 2, v10
v_xor_b32 v10, v8, v9
v_xor_b32 v10, s3, v10
v_lshlrev_b32 v10, 4, v10
v_lshl_add_u32 v8, v8, 3, v9
v_lshl_add_u32 v3, v8, 7, v10
v_bfe_u32 v8, v1, 1, 3
v_xor_b32 v8, s3, v8
v_lshlrev_b32 v8, 4, v8
v_lshl_add_u32 v5, v1, 7, v8
v_add_u32 v5, 65536, v5
s_lshl_b32 s64, s33, 3
s_add_u32 s64, s64, s3
s_lshl_b32 s56, s64, 13
v_and_b32 v8, 15, v1
v_lshlrev_b32 v8, 6, v8
v_bfe_u32 v9, v1, 4, 1
v_lshl_add_u32 v8, v9, 5, v8
v_lshrrev_b32 v9, 5, v1
v_lshl_add_u32 v8, v9, 4, v8
v_add_u32 v6, s56, v8
s_add_u32 s66, s24, 8912896
s_addc_u32 s67, s25, 0
s_mov_b32 s65, 0
s_cmp_lg_u32 s64, 0
s_cbranch_scc1 L_nsp_18
v_lshlrev_b32 v18, 4, v1
global_load_dwordx4 v[160:163], v18, s[66:67] offset:0 sc1
global_load_dwordx4 v[164:167], v18, s[66:67] offset:1024 sc1
global_load_dwordx4 v[168:171], v18, s[66:67] offset:2048 sc1
global_load_dwordx4 v[172:175], v18, s[66:67] offset:3072 sc1
v_add_u32 v18, 4096, v18
global_load_dwordx4 v[224:227], v18, s[66:67] offset:0 sc1
global_load_dwordx4 v[228:231], v18, s[66:67] offset:1024 sc1
global_load_dwordx4 v[232:235], v18, s[66:67] offset:2048 sc1
global_load_dwordx4 v[236:239], v18, s[66:67] offset:3072 sc1
v_add_u32 v18, 4096, v18
global_load_dwordx4 a[224:227], v18, s[66:67] offset:0 sc1
global_load_dwordx4 a[228:231], v18, s[66:67] offset:1024 sc1
global_load_dwordx4 a[232:235], v18, s[66:67] offset:2048 sc1
global_load_dwordx4 a[236:239], v18, s[66:67] offset:3072 sc1
v_add_u32 v18, 4096, v18
global_load_dwordx4 a[240:243], v18, s[66:67] offset:0 sc1
global_load_dwordx4 a[244:247], v18, s[66:67] offset:1024 sc1
global_load_dwordx4 a[248:251], v18, s[66:67] offset:2048 sc1
global_load_dwordx4 a[252:255], v18, s[66:67] offset:3072 sc1
v_add_u32 v18, 4096, v18
L_nsp_18:
s_waitcnt vmcnt(16)
s_barrier
L_fftcol_19:
ds_read_b64_tr_b16 v[112:113], v3 offset:0
ds_read_b64_tr_b16 v[114:115], v3 offset:8192
ds_read_b64_tr_b16 v[116:117], v3 offset:16384
ds_read_b64_tr_b16 v[118:119], v3 offset:24576
ds_read_b64_tr_b16 v[120:121], v3 offset:8
ds_read_b64_tr_b16 v[122:123], v3 offset:8200
ds_read_b64_tr_b16 v[124:125], v3 offset:16392
ds_read_b64_tr_b16 v[126:127], v3 offset:24584
ds_read_b64_tr_b16 v[176:177], v3 offset:32768
ds_read_b64_tr_b16 v[178:179], v3 offset:40960
ds_read_b64_tr_b16 v[180:181], v3 offset:49152
ds_read_b64_tr_b16 v[182:183], v3 offset:57344
ds_read_b64_tr_b16 v[184:185], v3 offset:32776
ds_read_b64_tr_b16 v[186:187], v3 offset:40968
ds_read_b64_tr_b16 v[188:189], v3 offset:49160
ds_read_b64_tr_b16 v[190:191], v3 offset:57352
s_waitcnt lgkmcnt(8)
v_mfma_f32_32x32x16_bf16 v[128:143], v[112:115], v[24:27], 0
v_mfma_f32_32x32x16_bf16 v[144:159], v[120:123], v[24:27], 0
v_mfma_f32_32x32x16_bf16 v[128:143], v[116:119], v[28:31], v[128:143]
v_mfma_f32_32x32x16_bf16 v[144:159], v[124:127], v[28:31], v[144:159]
v_mfma_f32_32x32x16_bf16 v[128:143], v[120:123], v[32:35], v[128:143]
v_mfma_f32_32x32x16_bf16 v[144:159], v[112:115], v[40:43], v[144:159]
v_mfma_f32_32x32x16_bf16 v[128:143], v[124:127], v[36:39], v[128:143]
v_mfma_f32_32x32x16_bf16 v[144:159], v[116:119], v[44:47], v[144:159]
s_waitcnt lgkmcnt(0)
s_nop 7
s_nop 3
v_mul_f32 v8, v128, v48
v_mul_f32 v12, v144, v48
v_mfma_f32_32x32x16_bf16 v[192:207], v[176:179], v[24:27], 0
v_fmac_f32 v8, v144, v64
v_fma_f32 v12, -v128, v64, v12
v_mul_f32 v9, v129, v49
v_mul_f32 v13, v145, v49
v_fmac_f32 v9, v145, v65
v_fma_f32 v13, -v129, v65, v13
v_mul_f32 v10, v130, v50
v_mul_f32 v14, v146, v50
v_mfma_f32_32x32x16_bf16 v[208:223], v[184:187], v[24:27], 0
v_fmac_f32 v10, v146, v66
v_fma_f32 v14, -v130, v66, v14
v_mul_f32 v11, v131, v51
v_mul_f32 v15, v147, v51
v_fmac_f32 v11, v147, v67
v_fma_f32 v15, -v131, v67, v15
v_cvt_pk_bf16_f32 v112, v8, v9
v_cvt_pk_bf16_f32 v113, v10, v11
v_mfma_f32_32x32x16_bf16 v[192:207], v[180:183], v[28:31], v[192:207]
v_cvt_pk_bf16_f32 v120, v12, v13
v_cvt_pk_bf16_f32 v121, v14, v15
v_mul_f32 v8, v132, v52
v_mul_f32 v12, v148, v52
v_fmac_f32 v8, v148, v68
v_fma_f32 v12, -v132, v68, v12
v_mul_f32 v9, v133, v53
v_mul_f32 v13, v149, v53
v_mfma_f32_32x32x16_bf16 v[208:223], v[188:191], v[28:31], v[208:223]
v_fmac_f32 v9, v149, v69
v_fma_f32 v13, -v133, v69, v13
v_mul_f32 v10, v134, v54
v_mul_f32 v14, v150, v54
v_fmac_f32 v10, v150, v70
v_fma_f32 v14, -v134, v70, v14
v_mul_f32 v11, v135, v55
v_mul_f32 v15, v151, v55
v_mfma_f32_32x32x16_bf16 v[192:207], v[184:187], v[32:35], v[192:207]
v_fmac_f32 v11, v151, v71
v_fma_f32 v15, -v135, v71, v15
v_cvt_pk_bf16_f32 v114, v8, v9
v_cvt_pk_bf16_f32 v115, v10, v11
v_cvt_pk_bf16_f32 v122, v12, v13
v_cvt_pk_bf16_f32 v123, v14, v15
v_mul_f32 v8, v136, v56
v_mul_f32 v12, v152, v56
v_mfma_f32_32x32x16_bf16 v[208:223], v[176:179], v[40:43], v[208:223]
v_fmac_f32 v8, v152, v72
v_fma_f32 v12, -v136, v72, v12
v_mul_f32 v9, v137, v57
v_mul_f32 v13, v153, v57
v_fmac_f32 v9, v153, v73
v_fma_f32 v13, -v137, v73, v13
v_mul_f32 v10, v138, v58
v_mul_f32 v14, v154, v58
v_mfma_f32_32x32x16_bf16 v[192:207], v[188:191], v[36:39], v[192:207]
v_fmac_f32 v10, v154, v74
v_fma_f32 v14, -v138, v74, v14
v_mul_f32 v11, v139, v59
v_mul_f32 v15, v155, v59
v_fmac_f32 v11, v155, v75
v_fma_f32 v15, -v139, v75, v15
v_cvt_pk_bf16_f32 v116, v8, v9
v_cvt_pk_bf16_f32 v117, v10, v11
v_mfma_f32_32x32x16_bf16 v[208:223], v[180:183], v[44:47], v[208:223]
v_cvt_pk_bf16_f32 v124, v12, v13
v_cvt_pk_bf16_f32 v125, v14, v15
v_mul_f32 v8, v140, v60
v_mul_f32 v12, v156, v60
v_fmac_f32 v8, v156, v76
v_fma_f32 v12, -v140, v76, v12
v_mul_f32 v9, v141, v61
v_mul_f32 v13, v157, v61
v_fmac_f32 v9, v157, v77
v_fma_f32 v13, -v141, v77, v13
v_mul_f32 v10, v142, v62
v_mul_f32 v14, v158, v62
v_fmac_f32 v10, v158, v78
v_fma_f32 v14, -v142, v78, v14
v_mul_f32 v11, v143, v63
v_mul_f32 v15, v159, v63
v_fmac_f32 v11, v159, v79
v_fma_f32 v15, -v143, v79, v15
v_cvt_pk_bf16_f32 v118, v8, v9
v_cvt_pk_bf16_f32 v119, v10, v11
v_cvt_pk_bf16_f32 v126, v12, v13
v_cvt_pk_bf16_f32 v127, v14, v15
s_cmp_lg_u32 s65, 0
s_cbranch_scc1 L_wok_20
s_waitcnt vmcnt(0)
s_barrier
L_wok_20:
s_cmp_eq_u32 s64, 0
s_cbranch_scc1 L_now_21
ds_read_b128 v[160:163], v5 offset:0
ds_read_b128 v[164:167], v5 offset:8192
ds_read_b128 v[168:171], v5 offset:16384
ds_read_b128 v[172:175], v5 offset:24576
ds_read_b128 v[224:227], v5 offset:32768
ds_read_b128 v[228:231], v5 offset:40960
ds_read_b128 v[232:235], v5 offset:49152
ds_read_b128 v[236:239], v5 offset:57344
L_now_21:
v_mul_f32 v8, v192, v48
v_mul_f32 v12, v208, v48
v_mfma_f32_32x32x16_bf16 v[128:143], v[24:27], v[112:115], 0
v_fmac_f32 v8, v208, v64
v_fma_f32 v12, -v192, v64, v12
v_mul_f32 v9, v193, v49
v_mul_f32 v13, v209, v49
v_fmac_f32 v9, v209, v65
v_fma_f32 v13, -v193, v65, v13
v_mul_f32 v10, v194, v50
v_mul_f32 v14, v210, v50
v_mfma_f32_32x32x16_bf16 v[144:159], v[24:27], v[120:123], 0
v_fmac_f32 v10, v210, v66
v_fma_f32 v14, -v194, v66, v14
v_mul_f32 v11, v195, v51
v_mul_f32 v15, v211, v51
v_fmac_f32 v11, v211, v67
v_fma_f32 v15, -v195, v67, v15
v_cvt_pk_bf16_f32 v176, v8, v9
v_cvt_pk_bf16_f32 v177, v10, v11
v_mfma_f32_32x32x16_bf16 v[128:143], v[28:31], v[116:119], v[128:143]
v_cvt_pk_bf16_f32 v184, v12, v13
v_cvt_pk_bf16_f32 v185, v14, v15
v_mul_f32 v8, v196, v52
v_mul_f32 v12, v212, v52
v_fmac_f32 v8, v212, v68
v_fma_f32 v12, -v196, v68, v12
v_mul_f32 v9, v197, v53
v_mul_f32 v13, v213, v53
v_mfma_f32_32x32x16_bf16 v[144:159], v[28:31], v[124:127], v[144:159]
v_fmac_f32 v9, v213, v69
v_fma_f32 v13, -v197, v69, v13
v_mul_f32 v10, v198, v54
v_mul_f32 v14, v214, v54
v_fmac_f32 v10, v214, v70
v_fma_f32 v14, -v198, v70, v14
v_mul_f32 v11, v199, v55
v_mul_f32 v15, v215, v55
v_mfma_f32_32x32x16_bf16 v[128:143], v[32:35], v[120:123], v[128:143]
v_fmac_f32 v11, v215, v71
v_fma_f32 v15, -v199, v71, v15
v_cvt_pk_bf16_f32 v178, v8, v9
v_cvt_pk_bf16_f32 v179, v10, v11
v_cvt_pk_bf16_f32 v186, v12, v13
v_cvt_pk_bf16_f32 v187, v14, v15
v_mul_f32 v8, v200, v56
v_mul_f32 v12, v216, v56
v_mfma_f32_32x32x16_bf16 v[144:159], v[40:43], v[112:115], v[144:159]
v_fmac_f32 v8, v216, v72
v_fma_f32 v12, -v200, v72, v12
v_mul_f32 v9, v201, v57
v_mul_f32 v13, v217, v57
v_fmac_f32 v9, v217, v73
v_fma_f32 v13, -v201, v73, v13
v_mul_f32 v10, v202, v58
v_mul_f32 v14, v218, v58
v_mfma_f32_32x32x16_bf16 v[128:143], v[36:39], v[124:127], v[128:143]
v_fmac_f32 v10, v218, v74
v_fma_f32 v14, -v202, v74, v14
v_mul_f32 v11, v203, v59
v_mul_f32 v15, v219, v59
v_fmac_f32 v11, v219, v75
v_fma_f32 v15, -v203, v75, v15
v_cvt_pk_bf16_f32 v180, v8, v9
v_cvt_pk_bf16_f32 v181, v10, v11
v_mfma_f32_32x32x16_bf16 v[144:159], v[44:47], v[116:119], v[144:159]
v_cvt_pk_bf16_f32 v188, v12, v13
v_cvt_pk_bf16_f32 v189, v14, v15
v_mul_f32 v8, v204, v60
v_mul_f32 v12, v220, v60
v_fmac_f32 v8, v220, v76
v_fma_f32 v12, -v204, v76, v12
v_mul_f32 v9, v205, v61
v_mul_f32 v13, v221, v61
v_fmac_f32 v9, v221, v77
v_fma_f32 v13, -v205, v77, v13
v_mul_f32 v10, v206, v62
v_mul_f32 v14, v222, v62
v_fmac_f32 v10, v222, v78
v_fma_f32 v14, -v206, v78, v14
v_mul_f32 v11, v207, v63
v_mul_f32 v15, v223, v63
v_fmac_f32 v11, v223, v79
v_fma_f32 v15, -v207, v79, v15
v_cvt_pk_bf16_f32 v182, v8, v9
v_cvt_pk_bf16_f32 v183, v10, v11
v_cvt_pk_bf16_f32 v190, v12, v13
v_cvt_pk_bf16_f32 v191, v14, v15
s_waitcnt lgkmcnt(0)
s_cmp_eq_u32 s64, 0
s_cbranch_scc1 L_spec_22
v_lshlrev_b32 v16, 16, v160
v_and_b32 v17, 0xffff0000, v160
v_mfma_f32_32x32x16_bf16 v[192:207], v[24:27], v[176:179], 0
v_mul_f32 v8, v128, v16
v_mul_f32 v12, v144, v16
v_fma_f32 v8, -v144, v17, v8
v_fmac_f32 v12, v128, v17
v_lshlrev_b32 v18, 16, v161
v_and_b32 v19, 0xffff0000, v161
v_mul_f32 v9, v129, v18
v_mul_f32 v13, v145, v18
v_fma_f32 v9, -v145, v19, v9
v_fmac_f32 v13, v129, v19
v_lshlrev_b32 v16, 16, v162
v_and_b32 v17, 0xffff0000, v162
v_mfma_f32_32x32x16_bf16 v[208:223], v[24:27], v[184:187], 0
v_mul_f32 v10, v130, v16
v_mul_f32 v14, v146, v16
v_fma_f32 v10, -v146, v17, v10
v_fmac_f32 v14, v130, v17
v_lshlrev_b32 v18, 16, v163
v_and_b32 v19, 0xffff0000, v163
v_mul_f32 v11, v131, v18
v_mul_f32 v15, v147, v18
v_fma_f32 v11, -v147, v19, v11
v_fmac_f32 v15, v131, v19
v_cvt_pk_bf16_f32 v112, v8, v9
v_cvt_pk_bf16_f32 v113, v10, v11
v_mfma_f32_32x32x16_bf16 v[192:207], v[28:31], v[180:183], v[192:207]
v_cvt_pk_bf16_f32 v120, v12, v13
v_cvt_pk_bf16_f32 v121, v14, v15
v_lshlrev_b32 v16, 16, v164
v_and_b32 v17, 0xffff0000, v164
v_mul_f32 v8, v132, v16
v_mul_f32 v12, v148, v16
v_fma_f32 v8, -v148, v17, v8
v_fmac_f32 v12, v132, v17
v_lshlrev_b32 v18, 16, v165
v_and_b32 v19, 0xffff0000, v165
v_mul_f32 v9, v133, v18
v_mul_f32 v13, v149, v18
v_mfma_f32_32x32x16_bf16 v[208:223], v[28:31], v[188:191], v[208:223]
v_fma_f32 v9, -v149, v19, v9
v_fmac_f32 v13, v133, v19
v_lshlrev_b32 v16, 16, v166
v_and_b32 v17, 0xffff0000, v166
v_mul_f32 v10, v134, v16
v_mul_f32 v14, v150, v16
v_fma_f32 v10, -v150, v17, v10
v_fmac_f32 v14, v134, v17
v_lshlrev_b32 v18, 16, v167
v_and_b32 v19, 0xffff0000, v167
v_mul_f32 v11, v135, v18
v_mul_f32 v15, v151, v18
v_mfma_f32_32x32x16_bf16 v[192:207], v[32:35], v[184:187], v[192:207]
v_fma_f32 v11, -v151, v19, v11
v_fmac_f32 v15, v135, v19
v_cvt_pk_bf16_f32 v114, v8, v9
v_cvt_pk_bf16_f32 v115, v10, v11
v_cvt_pk_bf16_f32 v122, v12, v13
v_cvt_pk_bf16_f32 v123, v14, v15
v_lshlrev_b32 v16, 16, v168
v_and_b32 v17, 0xffff0000, v168
v_mul_f32 v8, v136, v16
v_mul_f32 v12, v152, v16
v_fma_f32 v8, -v152, v17, v8
v_fmac_f32 v12, v136, v17
v_mfma_f32_32x32x16_bf16 v[208:223], v[40:43], v[176:179], v[208:223]
v_lshlrev_b32 v18, 16, v169
v_and_b32 v19, 0xffff0000, v169
v_mul_f32 v9, v137, v18
v_mul_f32 v13, v153, v18
v_fma_f32 v9, -v153, v19, v9
v_fmac_f32 v13, v137, v19
v_lshlrev_b32 v16, 16, v170
v_and_b32 v17, 0xffff0000, v170
v_mul_f32 v10, v138, v16
v_mul_f32 v14, v154, v16
v_fma_f32 v10, -v154, v17, v10
v_fmac_f32 v14, v138, v17
v_mfma_f32_32x32x16_bf16 v[192:207], v[36:39], v[188:191], v[192:207]
v_lshlrev_b32 v18, 16, v171
v_and_b32 v19, 0xffff0000, v171
v_mul_f32 v11, v139, v18
v_mul_f32 v15, v155, v18
v_fma_f32 v11, -v155, v19, v11
v_fmac_f32 v15, v139, v19
v_cvt_pk_bf16_f32 v116, v8, v9
v_cvt_pk_bf16_f32 v117, v10, v11
v_cvt_pk_bf16_f32 v124, v12, v13
v_cvt_pk_bf16_f32 v125, v14, v15
v_lshlrev_b32 v16, 16, v172
v_and_b32 v17, 0xffff0000, v172
v_mfma_f32_32x32x16_bf16 v[208:223], v[44:47], v[180:183], v[208:223]
v_mul_f32 v8, v140, v16
v_mul_f32 v12, v156, v16
v_fma_f32 v8, -v156, v17, v8
v_fmac_f32 v12, v140, v17
v_lshlrev_b32 v18, 16, v173
v_and_b32 v19, 0xffff0000, v173
v_mul_f32 v9, v141, v18
v_mul_f32 v13, v157, v18
v_fma_f32 v9, -v157, v19, v9
v_fmac_f32 v13, v141, v19
v_lshlrev_b32 v16, 16, v174
v_and_b32 v17, 0xffff0000, v174
v_mul_f32 v10, v142, v16
v_mul_f32 v14, v158, v16
v_fma_f32 v10, -v158, v17, v10
v_fmac_f32 v14, v142, v17
v_lshlrev_b32 v18, 16, v175
v_and_b32 v19, 0xffff0000, v175
v_mul_f32 v11, v143, v18
v_mul_f32 v15, v159, v18
v_fma_f32 v11, -v159, v19, v11
v_fmac_f32 v15, v143, v19
v_cvt_pk_bf16_f32 v118, v8, v9
v_cvt_pk_bf16_f32 v119, v10, v11
v_cvt_pk_bf16_f32 v126, v12, v13
v_cvt_pk_bf16_f32 v127, v14, v15
v_lshlrev_b32 v16, 16, v224
v_and_b32 v17, 0xffff0000, v224
v_mfma_f32_32x32x16_bf16 v[128:143], v[112:115], v[24:27], 0
v_mul_f32 v8, v192, v16
v_mul_f32 v12, v208, v16
v_fma_f32 v8, -v208, v17, v8
v_fmac_f32 v12, v192, v17
v_lshlrev_b32 v18, 16, v225
v_and_b32 v19, 0xffff0000, v225
v_mul_f32 v9, v193, v18
v_mul_f32 v13, v209, v18
v_fma_f32 v9, -v209, v19, v9
v_fmac_f32 v13, v193, v19
v_lshlrev_b32 v16, 16, v226
v_and_b32 v17, 0xffff0000, v226
v_mfma_f32_32x32x16_bf16 v[144:159], v[120:123], v[24:27], 0
v_mul_f32 v10, v194, v16
v_mul_f32 v14, v210, v16
v_fma_f32 v10, -v210, v17, v10
v_fmac_f32 v14, v194, v17
v_lshlrev_b32 v18, 16, v227
v_and_b32 v19, 0xffff0000, v227
v_mul_f32 v11, v195, v18
v_mul_f32 v15, v211, v18
v_fma_f32 v11, -v211, v19, v11
v_fmac_f32 v15, v195, v19
v_cvt_pk_bf16_f32 v176, v8, v9
v_cvt_pk_bf16_f32 v177, v10, v11
v_mfma_f32_32x32x16_bf16 v[128:143], v[116:119], v[28:31], v[128:143]
v_cvt_pk_bf16_f32 v184, v12, v13
v_cvt_pk_bf16_f32 v185, v14, v15
v_lshlrev_b32 v16, 16, v228
v_and_b32 v17, 0xffff0000, v228
v_mul_f32 v8, v196, v16
v_mul_f32 v12, v212, v16
v_fma_f32 v8, -v212, v17, v8
v_fmac_f32 v12, v196, v17
v_lshlrev_b32 v18, 16, v229
v_and_b32 v19, 0xffff0000, v229
v_mul_f32 v9, v197, v18
v_mul_f32 v13, v213, v18
v_mfma_f32_32x32x16_bf16 v[144:159], v[124:127], v[28:31], v[144:159]
v_fma_f32 v9, -v213, v19, v9
v_fmac_f32 v13, v197, v19
v_lshlrev_b32 v16, 16, v230
v_and_b32 v17, 0xffff0000, v230
v_mul_f32 v10, v198, v16
v_mul_f32 v14, v214, v16
v_fma_f32 v10, -v214, v17, v10
v_fmac_f32 v14, v198, v17
v_lshlrev_b32 v18, 16, v231
v_and_b32 v19, 0xffff0000, v231
v_mul_f32 v11, v199, v18
v_mul_f32 v15, v215, v18
v_mfma_f32_32x32x16_bf16 v[128:143], v[120:123], v[40:43], v[128:143]
v_fma_f32 v11, -v215, v19, v11
v_fmac_f32 v15, v199, v19
v_cvt_pk_bf16_f32 v178, v8, v9
v_cvt_pk_bf16_f32 v179, v10, v11
v_cvt_pk_bf16_f32 v186, v12, v13
v_cvt_pk_bf16_f32 v187, v14, v15
v_lshlrev_b32 v16, 16, v232
v_and_b32 v17, 0xffff0000, v232
v_mul_f32 v8, v200, v16
v_mul_f32 v12, v216, v16
v_fma_f32 v8, -v216, v17, v8
v_fmac_f32 v12, v200, v17
v_mfma_f32_32x32x16_bf16 v[144:159], v[112:115], v[32:35], v[144:159]
v_lshlrev_b32 v18, 16, v233
v_and_b32 v19, 0xffff0000, v233
v_mul_f32 v9, v201, v18
v_mul_f32 v13, v217, v18
v_fma_f32 v9, -v217, v19, v9
v_fmac_f32 v13, v201, v19
v_lshlrev_b32 v16, 16, v234
v_and_b32 v17, 0xffff0000, v234
v_mul_f32 v10, v202, v16
v_mul_f32 v14, v218, v16
v_fma_f32 v10, -v218, v17, v10
v_fmac_f32 v14, v202, v17
v_mfma_f32_32x32x16_bf16 v[128:143], v[124:127], v[44:47], v[128:143]
v_lshlrev_b32 v18, 16, v235
v_and_b32 v19, 0xffff0000, v235
v_mul_f32 v11, v203, v18
v_mul_f32 v15, v219, v18
v_fma_f32 v11, -v219, v19, v11
v_fmac_f32 v15, v203, v19
v_cvt_pk_bf16_f32 v180, v8, v9
v_cvt_pk_bf16_f32 v181, v10, v11
v_cvt_pk_bf16_f32 v188, v12, v13
v_cvt_pk_bf16_f32 v189, v14, v15
v_lshlrev_b32 v16, 16, v236
v_and_b32 v17, 0xffff0000, v236
v_mfma_f32_32x32x16_bf16 v[144:159], v[116:119], v[36:39], v[144:159]
v_mul_f32 v8, v204, v16
v_mul_f32 v12, v220, v16
v_fma_f32 v8, -v220, v17, v8
v_fmac_f32 v12, v204, v17
v_lshlrev_b32 v18, 16, v237
v_and_b32 v19, 0xffff0000, v237
v_mul_f32 v9, v205, v18
v_mul_f32 v13, v221, v18
v_fma_f32 v9, -v221, v19, v9
v_fmac_f32 v13, v205, v19
v_lshlrev_b32 v16, 16, v238
v_and_b32 v17, 0xffff0000, v238
v_mul_f32 v10, v206, v16
v_mul_f32 v14, v222, v16
v_fma_f32 v10, -v222, v17, v10
v_fmac_f32 v14, v206, v17
v_lshlrev_b32 v18, 16, v239
v_and_b32 v19, 0xffff0000, v239
v_mul_f32 v11, v207, v18
v_mul_f32 v15, v223, v18
v_fma_f32 v11, -v223, v19, v11
v_fmac_f32 v15, v207, v19
v_cvt_pk_bf16_f32 v182, v8, v9
v_cvt_pk_bf16_f32 v183, v10, v11
v_cvt_pk_bf16_f32 v190, v12, v13
v_cvt_pk_bf16_f32 v191, v14, v15
s_branch L_join_23
L_spec_22:
v_mfma_f32_32x32x16_bf16 v[192:207], v[24:27], v[176:179], 0
v_mfma_f32_32x32x16_bf16 v[208:223], v[24:27], v[184:187], 0
v_mfma_f32_32x32x16_bf16 v[192:207], v[28:31], v[180:183], v[192:207]
v_mfma_f32_32x32x16_bf16 v[208:223], v[28:31], v[188:191], v[208:223]
v_mfma_f32_32x32x16_bf16 v[192:207], v[32:35], v[184:187], v[192:207]
v_mfma_f32_32x32x16_bf16 v[208:223], v[40:43], v[176:179], v[208:223]
v_mfma_f32_32x32x16_bf16 v[192:207], v[36:39], v[188:191], v[192:207]
v_mfma_f32_32x32x16_bf16 v[208:223], v[44:47], v[180:183], v[208:223]
v_and_b32 v22, 31, v1
v_lshrrev_b32 v23, 5, v1
v_lshl_add_u32 v22, v23, 7, v22
v_lshlrev_b32 v23, 3, v22
v_add_u32 v23, 131072, v23
ds_write2_b32 v23, v128, v144 offset0:0 offset1:1
ds_write2_b32 v23, v129, v145 offset0:64 offset1:65
ds_write2_b32 v23, v130, v146 offset0:128 offset1:129
ds_write2_b32 v23, v131, v147 offset0:192 offset1:193
v_add_u32 v23, 2048, v23
ds_write2_b32 v23, v132, v148 offset0:0 offset1:1
ds_write2_b32 v23, v133, v149 offset0:64 offset1:65
ds_write2_b32 v23, v134, v150 offset0:128 offset1:129
ds_write2_b32 v23, v135, v151 offset0:192 offset1:193
v_add_u32 v23, 2048, v23
ds_write2_b32 v23, v136, v152 offset0:0 offset1:1
ds_write2_b32 v23, v137, v153 offset0:64 offset1:65
ds_write2_b32 v23, v138, v154 offset0:128 offset1:129
ds_write2_b32 v23, v139, v155 offset0:192 offset1:193
v_add_u32 v23, 2048, v23
ds_write2_b32 v23, v140, v156 offset0:0 offset1:1
ds_write2_b32 v23, v141, v157 offset0:64 offset1:65
ds_write2_b32 v23, v142, v158 offset0:128 offset1:129
ds_write2_b32 v23, v143, v159 offset0:192 offset1:193
s_mov_b64 exec, 1
v_mov_b32 v23, 139264
ds_write2_b32 v23, v128, v144 offset0:0 offset1:1
s_mov_b64 exec, -1
v_sub_u32 v23, 160, v22
v_lshlrev_b32 v23, 3, v23
v_add_u32 v23, 131072, v23
ds_read_b64 v[240:241], v23 offset:6912
ds_read_b64 v[242:243], v23 offset:6656
ds_read_b64 v[244:245], v23 offset:6400
ds_read_b64 v[246:247], v23 offset:6144
ds_read_b64 v[248:249], v23 offset:4864
ds_read_b64 v[250:251], v23 offset:4608
ds_read_b64 v[252:253], v23 offset:4352
ds_read_b64 v[254:255], v23 offset:4096
s_waitcnt lgkmcnt(4)
v_accvgpr_read_b32 v18, a224
v_lshlrev_b32 v16, 16, v160
v_and_b32 v17, 0xffff0000, v160
v_mul_f32 v8, v128, v16
v_mul_f32 v12, v144, v16
v_fma_f32 v8, -v144, v17, v8
v_fmac_f32 v12, v128, v17
v_lshlrev_b32 v16, 16, v18
v_and_b32 v17, 0xffff0000, v18
v_fmac_f32 v8, v240, v16
v_fmac_f32 v12, v240, v17
v_fmac_f32 v8, v241, v17
v_fma_f32 v12, -v241, v16, v12
v_accvgpr_read_b32 v18, a225
v_lshlrev_b32 v16, 16, v161
v_and_b32 v17, 0xffff0000, v161
v_mul_f32 v9, v129, v16
v_mul_f32 v13, v145, v16
v_fma_f32 v9, -v145, v17, v9
v_fmac_f32 v13, v129, v17
v_lshlrev_b32 v16, 16, v18
v_and_b32 v17, 0xffff0000, v18
v_fmac_f32 v9, v242, v16
v_fmac_f32 v13, v242, v17
v_fmac_f32 v9, v243, v17
v_fma_f32 v13, -v243, v16, v13
v_accvgpr_read_b32 v18, a226
v_lshlrev_b32 v16, 16, v162
v_and_b32 v17, 0xffff0000, v162
v_mul_f32 v10, v130, v16
v_mul_f32 v14, v146, v16
v_fma_f32 v10, -v146, v17, v10
v_fmac_f32 v14, v130, v17
v_lshlrev_b32 v16, 16, v18
v_and_b32 v17, 0xffff0000, v18
v_fmac_f32 v10, v244, v16
v_fmac_f32 v14, v244, v17
v_fmac_f32 v10, v245, v17
v_fma_f32 v14, -v245, v16, v14
v_accvgpr_read_b32 v18, a227
v_lshlrev_b32 v16, 16, v163
v_and_b32 v17, 0xffff0000, v163
v_mul_f32 v11, v131, v16
v_mul_f32 v15, v147, v16
v_fma_f32 v11, -v147, v17, v11
v_fmac_f32 v15, v131, v17
v_lshlrev_b32 v16, 16, v18
v_and_b32 v17, 0xffff0000, v18
v_fmac_f32 v11, v246, v16
v_fmac_f32 v15, v246, v17
v_fmac_f32 v11, v247, v17
v_fma_f32 v15, -v247, v16, v15
v_cvt_pk_bf16_f32 v112, v8, v9
v_cvt_pk_bf16_f32 v113, v10, v11
v_cvt_pk_bf16_f32 v120, v12, v13
v_cvt_pk_bf16_f32 v121, v14, v15
ds_read_b64 v[240:241], v23 offset:2816
ds_read_b64 v[242:243], v23 offset:2560
ds_read_b64 v[244:245], v23 offset:2304
ds_read_b64 v[246:247], v23 offset:2048
s_waitcnt lgkmcnt(4)
v_accvgpr_read_b32 v18, a228
v_lshlrev_b32 v16, 16, v164
v_and_b32 v17, 0xffff0000, v164
v_mul_f32 v8, v132, v16
v_mul_f32 v12, v148, v16
v_fma_f32 v8, -v148, v17, v8
v_fmac_f32 v12, v132, v17
v_lshlrev_b32 v16, 16, v18
v_and_b32 v17, 0xffff0000, v18
v_fmac_f32 v8, v248, v16
v_fmac_f32 v12, v248, v17
v_fmac_f32 v8, v249, v17
v_fma_f32 v12, -v249, v16, v12
v_accvgpr_read_b32 v18, a229
v_lshlrev_b32 v16, 16, v165
v_and_b32 v17, 0xffff0000, v165
v_mul_f32 v9, v133, v16
v_mul_f32 v13, v149, v16
v_fma_f32 v9, -v149, v17, v9
v_fmac_f32 v13, v133, v17
v_lshlrev_b32 v16, 16, v18
v_and_b32 v17, 0xffff0000, v18
v_fmac_f32 v9, v250, v16
v_fmac_f32 v13, v250, v17
v_fmac_f32 v9, v251, v17
v_fma_f32 v13, -v251, v16, v13
v_accvgpr_read_b32 v18, a230
v_lshlrev_b32 v16, 16, v166
v_and_b32 v17, 0xffff0000, v166
v_mul_f32 v10, v134, v16
v_mul_f32 v14, v150, v16
v_fma_f32 v10, -v150, v17, v10
v_fmac_f32 v14, v134, v17
v_lshlrev_b32 v16, 16, v18
v_and_b32 v17, 0xffff0000, v18
v_fmac_f32 v10, v252, v16
v_fmac_f32 v14, v252, v17
v_fmac_f32 v10, v253, v17
v_fma_f32 v14, -v253, v16, v14
v_accvgpr_read_b32 v18, a231
v_lshlrev_b32 v16, 16, v167
v_and_b32 v17, 0xffff0000, v167
v_mul_f32 v11, v135, v16
v_mul_f32 v15, v151, v16
v_fma_f32 v11, -v151, v17, v11
v_fmac_f32 v15, v135, v17
v_lshlrev_b32 v16, 16, v18
v_and_b32 v17, 0xffff0000, v18
v_fmac_f32 v11, v254, v16
v_fmac_f32 v15, v254, v17
v_fmac_f32 v11, v255, v17
v_fma_f32 v15, -v255, v16, v15
v_cvt_pk_bf16_f32 v114, v8, v9
v_cvt_pk_bf16_f32 v115, v10, v11
v_cvt_pk_bf16_f32 v122, v12, v13
v_cvt_pk_bf16_f32 v123, v14, v15
ds_read_b64 v[248:249], v23 offset:768
ds_read_b64 v[250:251], v23 offset:512
ds_read_b64 v[252:253], v23 offset:256
ds_read_b64 v[254:255], v23 offset:0
s_waitcnt lgkmcnt(4)
v_accvgpr_read_b32 v18, a232
v_lshlrev_b32 v16, 16, v168
v_and_b32 v17, 0xffff0000, v168
v_mul_f32 v8, v136, v16
v_mul_f32 v12, v152, v16
v_fma_f32 v8, -v152, v17, v8
v_fmac_f32 v12, v136, v17
v_lshlrev_b32 v16, 16, v18
v_and_b32 v17, 0xffff0000, v18
v_fmac_f32 v8, v240, v16
v_fmac_f32 v12, v240, v17
v_fmac_f32 v8, v241, v17
v_fma_f32 v12, -v241, v16, v12
v_accvgpr_read_b32 v18, a233
v_lshlrev_b32 v16, 16, v169
v_and_b32 v17, 0xffff0000, v169
v_mul_f32 v9, v137, v16
v_mul_f32 v13, v153, v16
v_fma_f32 v9, -v153, v17, v9
v_fmac_f32 v13, v137, v17
v_lshlrev_b32 v16, 16, v18
v_and_b32 v17, 0xffff0000, v18
v_fmac_f32 v9, v242, v16
v_fmac_f32 v13, v242, v17
v_fmac_f32 v9, v243, v17
v_fma_f32 v13, -v243, v16, v13
v_accvgpr_read_b32 v18, a234
v_lshlrev_b32 v16, 16, v170
v_and_b32 v17, 0xffff0000, v170
v_mul_f32 v10, v138, v16
v_mul_f32 v14, v154, v16
v_fma_f32 v10, -v154, v17, v10
v_fmac_f32 v14, v138, v17
v_lshlrev_b32 v16, 16, v18
v_and_b32 v17, 0xffff0000, v18
v_fmac_f32 v10, v244, v16
v_fmac_f32 v14, v244, v17
v_fmac_f32 v10, v245, v17
v_fma_f32 v14, -v245, v16, v14
v_accvgpr_read_b32 v18, a235
v_lshlrev_b32 v16, 16, v171
v_and_b32 v17, 0xffff0000, v171
v_mul_f32 v11, v139, v16
v_mul_f32 v15, v155, v16
v_fma_f32 v11, -v155, v17, v11
v_fmac_f32 v15, v139, v17
v_lshlrev_b32 v16, 16, v18
v_and_b32 v17, 0xffff0000, v18
v_fmac_f32 v11, v246, v16
v_fmac_f32 v15, v246, v17
v_fmac_f32 v11, v247, v17
v_fma_f32 v15, -v247, v16, v15
v_cvt_pk_bf16_f32 v116, v8, v9
v_cvt_pk_bf16_f32 v117, v10, v11
v_cvt_pk_bf16_f32 v124, v12, v13
v_cvt_pk_bf16_f32 v125, v14, v15
s_waitcnt lgkmcnt(0)
v_accvgpr_read_b32 v18, a236
v_lshlrev_b32 v16, 16, v172
v_and_b32 v17, 0xffff0000, v172
v_mul_f32 v8, v140, v16
v_mul_f32 v12, v156, v16
v_fma_f32 v8, -v156, v17, v8
v_fmac_f32 v12, v140, v17
v_lshlrev_b32 v16, 16, v18
v_and_b32 v17, 0xffff0000, v18
v_fmac_f32 v8, v248, v16
v_fmac_f32 v12, v248, v17
v_fmac_f32 v8, v249, v17
v_fma_f32 v12, -v249, v16, v12
v_accvgpr_read_b32 v18, a237
v_lshlrev_b32 v16, 16, v173
v_and_b32 v17, 0xffff0000, v173
v_mul_f32 v9, v141, v16
v_mul_f32 v13, v157, v16
v_fma_f32 v9, -v157, v17, v9
v_fmac_f32 v13, v141, v17
v_lshlrev_b32 v16, 16, v18
v_and_b32 v17, 0xffff0000, v18
v_fmac_f32 v9, v250, v16
v_fmac_f32 v13, v250, v17
v_fmac_f32 v9, v251, v17
v_fma_f32 v13, -v251, v16, v13
v_accvgpr_read_b32 v18, a238
v_lshlrev_b32 v16, 16, v174
v_and_b32 v17, 0xffff0000, v174
v_mul_f32 v10, v142, v16
v_mul_f32 v14, v158, v16
v_fma_f32 v10, -v158, v17, v10
v_fmac_f32 v14, v142, v17
v_lshlrev_b32 v16, 16, v18
v_and_b32 v17, 0xffff0000, v18
v_fmac_f32 v10, v252, v16
v_fmac_f32 v14, v252, v17
v_fmac_f32 v10, v253, v17
v_fma_f32 v14, -v253, v16, v14
v_accvgpr_read_b32 v18, a239
v_lshlrev_b32 v16, 16, v175
v_and_b32 v17, 0xffff0000, v175
v_mul_f32 v11, v143, v16
v_mul_f32 v15, v159, v16
v_fma_f32 v11, -v159, v17, v11
v_fmac_f32 v15, v143, v17
v_lshlrev_b32 v16, 16, v18
v_and_b32 v17, 0xffff0000, v18
v_fmac_f32 v11, v254, v16
v_fmac_f32 v15, v254, v17
v_fmac_f32 v11, v255, v17
v_fma_f32 v15, -v255, v16, v15
v_cvt_pk_bf16_f32 v118, v8, v9
v_cvt_pk_bf16_f32 v119, v10, v11
v_cvt_pk_bf16_f32 v126, v12, v13
v_cvt_pk_bf16_f32 v127, v14, v15
s_nop 1
v_mfma_f32_32x32x16_bf16 v[128:143], v[112:115], v[24:27], 0
v_mfma_f32_32x32x16_bf16 v[144:159], v[120:123], v[24:27], 0
v_mfma_f32_32x32x16_bf16 v[128:143], v[116:119], v[28:31], v[128:143]
v_mfma_f32_32x32x16_bf16 v[144:159], v[124:127], v[28:31], v[144:159]
v_mfma_f32_32x32x16_bf16 v[128:143], v[120:123], v[40:43], v[128:143]
v_mfma_f32_32x32x16_bf16 v[144:159], v[112:115], v[32:35], v[144:159]
v_mfma_f32_32x32x16_bf16 v[128:143], v[124:127], v[44:47], v[128:143]
v_mfma_f32_32x32x16_bf16 v[144:159], v[116:119], v[36:39], v[144:159]
v_and_b32 v22, 31, v1
v_lshrrev_b32 v23, 5, v1
v_lshl_add_u32 v22, v23, 7, v22
v_lshlrev_b32 v23, 3, v22
v_add_u32 v23, 131072, v23
ds_write2_b32 v23, v192, v208 offset0:0 offset1:1
ds_write2_b32 v23, v193, v209 offset0:64 offset1:65
ds_write2_b32 v23, v194, v210 offset0:128 offset1:129
ds_write2_b32 v23, v195, v211 offset0:192 offset1:193
v_add_u32 v23, 2048, v23
ds_write2_b32 v23, v196, v212 offset0:0 offset1:1
ds_write2_b32 v23, v197, v213 offset0:64 offset1:65
ds_write2_b32 v23, v198, v214 offset0:128 offset1:129
ds_write2_b32 v23, v199, v215 offset0:192 offset1:193
v_add_u32 v23, 2048, v23
ds_write2_b32 v23, v200, v216 offset0:0 offset1:1
ds_write2_b32 v23, v201, v217 offset0:64 offset1:65
ds_write2_b32 v23, v202, v218 offset0:128 offset1:129
ds_write2_b32 v23, v203, v219 offset0:192 offset1:193
v_add_u32 v23, 2048, v23
ds_write2_b32 v23, v204, v220 offset0:0 offset1:1
ds_write2_b32 v23, v205, v221 offset0:64 offset1:65
ds_write2_b32 v23, v206, v222 offset0:128 offset1:129
ds_write2_b32 v23, v207, v223 offset0:192 offset1:193
v_sub_u32 v23, 159, v22
v_lshlrev_b32 v23, 3, v23
v_add_u32 v23, 131072, v23
ds_read_b64 v[240:241], v23 offset:6912
ds_read_b64 v[242:243], v23 offset:6656
ds_read_b64 v[244:245], v23 offset:6400
ds_read_b64 v[246:247], v23 offset:6144
ds_read_b64 v[248:249], v23 offset:4864
ds_read_b64 v[250:251], v23 offset:4608
ds_read_b64 v[252:253], v23 offset:4352
ds_read_b64 v[254:255], v23 offset:4096
s_waitcnt lgkmcnt(4)
v_accvgpr_read_b32 v18, a240
v_lshlrev_b32 v16, 16, v224
v_and_b32 v17, 0xffff0000, v224
v_mul_f32 v8, v192, v16
v_mul_f32 v12, v208, v16
v_fma_f32 v8, -v208, v17, v8
v_fmac_f32 v12, v192, v17
v_lshlrev_b32 v16, 16, v18
v_and_b32 v17, 0xffff0000, v18
v_fmac_f32 v8, v240, v16
v_fmac_f32 v12, v240, v17
v_fmac_f32 v8, v241, v17
v_fma_f32 v12, -v241, v16, v12
v_accvgpr_read_b32 v18, a241
v_lshlrev_b32 v16, 16, v225
v_and_b32 v17, 0xffff0000, v225
v_mul_f32 v9, v193, v16
v_mul_f32 v13, v209, v16
v_fma_f32 v9, -v209, v17, v9
v_fmac_f32 v13, v193, v17
v_lshlrev_b32 v16, 16, v18
v_and_b32 v17, 0xffff0000, v18
v_fmac_f32 v9, v242, v16
v_fmac_f32 v13, v242, v17
v_fmac_f32 v9, v243, v17
v_fma_f32 v13, -v243, v16, v13
v_accvgpr_read_b32 v18, a242
v_lshlrev_b32 v16, 16, v226
v_and_b32 v17, 0xffff0000, v226
v_mul_f32 v10, v194, v16
v_mul_f32 v14, v210, v16
v_fma_f32 v10, -v210, v17, v10
v_fmac_f32 v14, v194, v17
v_lshlrev_b32 v16, 16, v18
v_and_b32 v17, 0xffff0000, v18
v_fmac_f32 v10, v244, v16
v_fmac_f32 v14, v244, v17
v_fmac_f32 v10, v245, v17
v_fma_f32 v14, -v245, v16, v14
v_accvgpr_read_b32 v18, a243
v_lshlrev_b32 v16, 16, v227
v_and_b32 v17, 0xffff0000, v227
v_mul_f32 v11, v195, v16
v_mul_f32 v15, v211, v16
v_fma_f32 v11, -v211, v17, v11
v_fmac_f32 v15, v195, v17
v_lshlrev_b32 v16, 16, v18
v_and_b32 v17, 0xffff0000, v18
v_fmac_f32 v11, v246, v16
v_fmac_f32 v15, v246, v17
v_fmac_f32 v11, v247, v17
v_fma_f32 v15, -v247, v16, v15
v_cvt_pk_bf16_f32 v176, v8, v9
v_cvt_pk_bf16_f32 v177, v10, v11
v_cvt_pk_bf16_f32 v184, v12, v13
v_cvt_pk_bf16_f32 v185, v14, v15
ds_read_b64 v[240:241], v23 offset:2816
ds_read_b64 v[242:243], v23 offset:2560
ds_read_b64 v[244:245], v23 offset:2304
ds_read_b64 v[246:247], v23 offset:2048
s_waitcnt lgkmcnt(4)
v_accvgpr_read_b32 v18, a244
v_lshlrev_b32 v16, 16, v228
v_and_b32 v17, 0xffff0000, v228
v_mul_f32 v8, v196, v16
v_mul_f32 v12, v212, v16
v_fma_f32 v8, -v212, v17, v8
v_fmac_f32 v12, v196, v17
v_lshlrev_b32 v16, 16, v18
v_and_b32 v17, 0xffff0000, v18
v_fmac_f32 v8, v248, v16
v_fmac_f32 v12, v248, v17
v_fmac_f32 v8, v249, v17
v_fma_f32 v12, -v249, v16, v12
v_accvgpr_read_b32 v18, a245
v_lshlrev_b32 v16, 16, v229
v_and_b32 v17, 0xffff0000, v229
v_mul_f32 v9, v197, v16
v_mul_f32 v13, v213, v16
v_fma_f32 v9, -v213, v17, v9
v_fmac_f32 v13, v197, v17
v_lshlrev_b32 v16, 16, v18
v_and_b32 v17, 0xffff0000, v18
v_fmac_f32 v9, v250, v16
v_fmac_f32 v13, v250, v17
v_fmac_f32 v9, v251, v17
v_fma_f32 v13, -v251, v16, v13
v_accvgpr_read_b32 v18, a246
v_lshlrev_b32 v16, 16, v230
v_and_b32 v17, 0xffff0000, v230
v_mul_f32 v10, v198, v16
v_mul_f32 v14, v214, v16
v_fma_f32 v10, -v214, v17, v10
v_fmac_f32 v14, v198, v17
v_lshlrev_b32 v16, 16, v18
v_and_b32 v17, 0xffff0000, v18
v_fmac_f32 v10, v252, v16
v_fmac_f32 v14, v252, v17
v_fmac_f32 v10, v253, v17
v_fma_f32 v14, -v253, v16, v14
v_accvgpr_read_b32 v18, a247
v_lshlrev_b32 v16, 16, v231
v_and_b32 v17, 0xffff0000, v231
v_mul_f32 v11, v199, v16
v_mul_f32 v15, v215, v16
v_fma_f32 v11, -v215, v17, v11
v_fmac_f32 v15, v199, v17
v_lshlrev_b32 v16, 16, v18
v_and_b32 v17, 0xffff0000, v18
v_fmac_f32 v11, v254, v16
v_fmac_f32 v15, v254, v17
v_fmac_f32 v11, v255, v17
v_fma_f32 v15, -v255, v16, v15
v_cvt_pk_bf16_f32 v178, v8, v9
v_cvt_pk_bf16_f32 v179, v10, v11
v_cvt_pk_bf16_f32 v186, v12, v13
v_cvt_pk_bf16_f32 v187, v14, v15
ds_read_b64 v[248:249], v23 offset:768
ds_read_b64 v[250:251], v23 offset:512
ds_read_b64 v[252:253], v23 offset:256
ds_read_b64 v[254:255], v23 offset:0
s_waitcnt lgkmcnt(4)
v_accvgpr_read_b32 v18, a248
v_lshlrev_b32 v16, 16, v232
v_and_b32 v17, 0xffff0000, v232
v_mul_f32 v8, v200, v16
v_mul_f32 v12, v216, v16
v_fma_f32 v8, -v216, v17, v8
v_fmac_f32 v12, v200, v17
v_lshlrev_b32 v16, 16, v18
v_and_b32 v17, 0xffff0000, v18
v_fmac_f32 v8, v240, v16
v_fmac_f32 v12, v240, v17
v_fmac_f32 v8, v241, v17
v_fma_f32 v12, -v241, v16, v12
v_accvgpr_read_b32 v18, a249
v_lshlrev_b32 v16, 16, v233
v_and_b32 v17, 0xffff0000, v233
v_mul_f32 v9, v201, v16
v_mul_f32 v13, v217, v16
v_fma_f32 v9, -v217, v17, v9
v_fmac_f32 v13, v201, v17
v_lshlrev_b32 v16, 16, v18
v_and_b32 v17, 0xffff0000, v18
v_fmac_f32 v9, v242, v16
v_fmac_f32 v13, v242, v17
v_fmac_f32 v9, v243, v17
v_fma_f32 v13, -v243, v16, v13
v_accvgpr_read_b32 v18, a250
v_lshlrev_b32 v16, 16, v234
v_and_b32 v17, 0xffff0000, v234
v_mul_f32 v10, v202, v16
v_mul_f32 v14, v218, v16
v_fma_f32 v10, -v218, v17, v10
v_fmac_f32 v14, v202, v17
v_lshlrev_b32 v16, 16, v18
v_and_b32 v17, 0xffff0000, v18
v_fmac_f32 v10, v244, v16
v_fmac_f32 v14, v244, v17
v_fmac_f32 v10, v245, v17
v_fma_f32 v14, -v245, v16, v14
v_accvgpr_read_b32 v18, a251
v_lshlrev_b32 v16, 16, v235
v_and_b32 v17, 0xffff0000, v235
v_mul_f32 v11, v203, v16
v_mul_f32 v15, v219, v16
v_fma_f32 v11, -v219, v17, v11
v_fmac_f32 v15, v203, v17
v_lshlrev_b32 v16, 16, v18
v_and_b32 v17, 0xffff0000, v18
v_fmac_f32 v11, v246, v16
v_fmac_f32 v15, v246, v17
v_fmac_f32 v11, v247, v17
v_fma_f32 v15, -v247, v16, v15
v_cvt_pk_bf16_f32 v180, v8, v9
v_cvt_pk_bf16_f32 v181, v10, v11
v_cvt_pk_bf16_f32 v188, v12, v13
v_cvt_pk_bf16_f32 v189, v14, v15
s_waitcnt lgkmcnt(0)
v_accvgpr_read_b32 v18, a252
v_lshlrev_b32 v16, 16, v236
v_and_b32 v17, 0xffff0000, v236
v_mul_f32 v8, v204, v16
v_mul_f32 v12, v220, v16
v_fma_f32 v8, -v220, v17, v8
v_fmac_f32 v12, v204, v17
v_lshlrev_b32 v16, 16, v18
v_and_b32 v17, 0xffff0000, v18
v_fmac_f32 v8, v248, v16
v_fmac_f32 v12, v248, v17
v_fmac_f32 v8, v249, v17
v_fma_f32 v12, -v249, v16, v12
v_accvgpr_read_b32 v18, a253
v_lshlrev_b32 v16, 16, v237
v_and_b32 v17, 0xffff0000, v237
v_mul_f32 v9, v205, v16
v_mul_f32 v13, v221, v16
v_fma_f32 v9, -v221, v17, v9
v_fmac_f32 v13, v205, v17
v_lshlrev_b32 v16, 16, v18
v_and_b32 v17, 0xffff0000, v18
v_fmac_f32 v9, v250, v16
v_fmac_f32 v13, v250, v17
v_fmac_f32 v9, v251, v17
v_fma_f32 v13, -v251, v16, v13
v_accvgpr_read_b32 v18, a254
v_lshlrev_b32 v16, 16, v238
v_and_b32 v17, 0xffff0000, v238
v_mul_f32 v10, v206, v16
v_mul_f32 v14, v222, v16
v_fma_f32 v10, -v222, v17, v10
v_fmac_f32 v14, v206, v17
v_lshlrev_b32 v16, 16, v18
v_and_b32 v17, 0xffff0000, v18
v_fmac_f32 v10, v252, v16
v_fmac_f32 v14, v252, v17
v_fmac_f32 v10, v253, v17
v_fma_f32 v14, -v253, v16, v14
v_accvgpr_read_b32 v18, a255
v_lshlrev_b32 v16, 16, v239
v_and_b32 v17, 0xffff0000, v239
v_mul_f32 v11, v207, v16
v_mul_f32 v15, v223, v16
v_fma_f32 v11, -v223, v17, v11
v_fmac_f32 v15, v207, v17
v_lshlrev_b32 v16, 16, v18
v_and_b32 v17, 0xffff0000, v18
v_fmac_f32 v11, v254, v16
v_fmac_f32 v15, v254, v17
v_fmac_f32 v11, v255, v17
v_fma_f32 v15, -v255, v16, v15
v_cvt_pk_bf16_f32 v182, v8, v9
v_cvt_pk_bf16_f32 v183, v10, v11
v_cvt_pk_bf16_f32 v190, v12, v13
v_cvt_pk_bf16_f32 v191, v14, v15
s_nop 1
s_nop 7
s_nop 3
L_join_23:
v_mul_f32 v8, v128, v48
v_mul_f32 v12, v144, v48
v_mfma_f32_32x32x16_bf16 v[192:207], v[176:179], v[24:27], 0
v_fma_f32 v8, -v144, v64, v8
v_fmac_f32 v12, v128, v64
v_mul_f32 v9, v129, v49
v_mul_f32 v13, v145, v49
v_fma_f32 v9, -v145, v65, v9
v_fmac_f32 v13, v129, v65
v_mul_f32 v10, v130, v50
v_mul_f32 v14, v146, v50
v_mfma_f32_32x32x16_bf16 v[208:223], v[184:187], v[24:27], 0
v_fma_f32 v10, -v146, v66, v10
v_fmac_f32 v14, v130, v66
v_mul_f32 v11, v131, v51
v_mul_f32 v15, v147, v51
v_fma_f32 v11, -v147, v67, v11
v_fmac_f32 v15, v131, v67
v_cvt_pk_bf16_f32 v112, v8, v9
v_cvt_pk_bf16_f32 v113, v10, v11
v_mfma_f32_32x32x16_bf16 v[192:207], v[180:183], v[28:31], v[192:207]
v_cvt_pk_bf16_f32 v120, v12, v13
v_cvt_pk_bf16_f32 v121, v14, v15
v_mul_f32 v8, v132, v52
v_mul_f32 v12, v148, v52
v_fma_f32 v8, -v148, v68, v8
v_fmac_f32 v12, v132, v68
v_mul_f32 v9, v133, v53
v_mul_f32 v13, v149, v53
v_mfma_f32_32x32x16_bf16 v[208:223], v[188:191], v[28:31], v[208:223]
v_fma_f32 v9, -v149, v69, v9
v_fmac_f32 v13, v133, v69
v_mul_f32 v10, v134, v54
v_mul_f32 v14, v150, v54
v_fma_f32 v10, -v150, v70, v10
v_fmac_f32 v14, v134, v70
v_mul_f32 v11, v135, v55
v_mul_f32 v15, v151, v55
v_mfma_f32_32x32x16_bf16 v[192:207], v[184:187], v[40:43], v[192:207]
v_fma_f32 v11, -v151, v71, v11
v_fmac_f32 v15, v135, v71
v_cvt_pk_bf16_f32 v114, v8, v9
v_cvt_pk_bf16_f32 v115, v10, v11
v_cvt_pk_bf16_f32 v122, v12, v13
v_cvt_pk_bf16_f32 v123, v14, v15
v_mul_f32 v8, v136, v56
v_mul_f32 v12, v152, v56
v_mfma_f32_32x32x16_bf16 v[208:223], v[176:179], v[32:35], v[208:223]
v_fma_f32 v8, -v152, v72, v8
v_fmac_f32 v12, v136, v72
v_mul_f32 v9, v137, v57
v_mul_f32 v13, v153, v57
v_fma_f32 v9, -v153, v73, v9
v_fmac_f32 v13, v137, v73
v_mul_f32 v10, v138, v58
v_mul_f32 v14, v154, v58
v_mfma_f32_32x32x16_bf16 v[192:207], v[188:191], v[44:47], v[192:207]
v_fma_f32 v10, -v154, v74, v10
v_fmac_f32 v14, v138, v74
v_mul_f32 v11, v139, v59
v_mul_f32 v15, v155, v59
v_fma_f32 v11, -v155, v75, v11
v_fmac_f32 v15, v139, v75
v_cvt_pk_bf16_f32 v116, v8, v9
v_cvt_pk_bf16_f32 v117, v10, v11
v_mfma_f32_32x32x16_bf16 v[208:223], v[180:183], v[36:39], v[208:223]
v_cvt_pk_bf16_f32 v124, v12, v13
v_cvt_pk_bf16_f32 v125, v14, v15
v_mul_f32 v8, v140, v60
v_mul_f32 v12, v156, v60
v_fma_f32 v8, -v156, v76, v8
v_fmac_f32 v12, v140, v76
v_mul_f32 v9, v141, v61
v_mul_f32 v13, v157, v61
v_fma_f32 v9, -v157, v77, v9
v_fmac_f32 v13, v141, v77
v_mul_f32 v10, v142, v62
v_mul_f32 v14, v158, v62
v_fma_f32 v10, -v158, v78, v10
v_fmac_f32 v14, v142, v78
v_mul_f32 v11, v143, v63
v_mul_f32 v15, v159, v63
v_fma_f32 v11, -v159, v79, v11
v_fmac_f32 v15, v143, v79
v_cvt_pk_bf16_f32 v118, v8, v9
v_cvt_pk_bf16_f32 v119, v10, v11
v_cvt_pk_bf16_f32 v126, v12, v13
v_cvt_pk_bf16_f32 v127, v14, v15
v_mul_f32 v8, v192, v48
v_mul_f32 v12, v208, v48
v_mfma_f32_32x32x16_bf16 v[128:143], v[112:115], v[24:27], 0
v_fma_f32 v8, -v208, v64, v8
v_fmac_f32 v12, v192, v64
v_mul_f32 v9, v193, v49
v_mul_f32 v13, v209, v49
v_fma_f32 v9, -v209, v65, v9
v_fmac_f32 v13, v193, v65
v_mul_f32 v10, v194, v50
v_mul_f32 v14, v210, v50
v_mfma_f32_32x32x16_bf16 v[144:159], v[120:123], v[24:27], 0
v_fma_f32 v10, -v210, v66, v10
v_fmac_f32 v14, v194, v66
v_mul_f32 v11, v195, v51
v_mul_f32 v15, v211, v51
v_fma_f32 v11, -v211, v67, v11
v_fmac_f32 v15, v195, v67
v_cvt_pk_bf16_f32 v176, v8, v9
v_cvt_pk_bf16_f32 v177, v10, v11
v_mfma_f32_32x32x16_bf16 v[128:143], v[116:119], v[28:31], v[128:143]
v_cvt_pk_bf16_f32 v184, v12, v13
v_cvt_pk_bf16_f32 v185, v14, v15
v_mul_f32 v8, v196, v52
v_mul_f32 v12, v212, v52
v_fma_f32 v8, -v212, v68, v8
v_fmac_f32 v12, v196, v68
v_mul_f32 v9, v197, v53
v_mul_f32 v13, v213, v53
v_mfma_f32_32x32x16_bf16 v[144:159], v[124:127], v[28:31], v[144:159]
v_fma_f32 v9, -v213, v69, v9
v_fmac_f32 v13, v197, v69
v_mul_f32 v10, v198, v54
v_mul_f32 v14, v214, v54
v_fma_f32 v10, -v214, v70, v10
v_fmac_f32 v14, v198, v70
v_mul_f32 v11, v199, v55
v_mul_f32 v15, v215, v55
v_mfma_f32_32x32x16_bf16 v[128:143], v[120:123], v[40:43], v[128:143]
v_fma_f32 v11, -v215, v71, v11
v_fmac_f32 v15, v199, v71
v_cvt_pk_bf16_f32 v178, v8, v9
v_cvt_pk_bf16_f32 v179, v10, v11
v_cvt_pk_bf16_f32 v186, v12, v13
v_cvt_pk_bf16_f32 v187, v14, v15
v_mul_f32 v8, v200, v56
v_mul_f32 v12, v216, v56
v_mfma_f32_32x32x16_bf16 v[144:159], v[112:115], v[32:35], v[144:159]
v_fma_f32 v8, -v216, v72, v8
v_fmac_f32 v12, v200, v72
v_mul_f32 v9, v201, v57
v_mul_f32 v13, v217, v57
v_fma_f32 v9, -v217, v73, v9
v_fmac_f32 v13, v201, v73
v_mul_f32 v10, v202, v58
v_mul_f32 v14, v218, v58
v_mfma_f32_32x32x16_bf16 v[128:143], v[124:127], v[44:47], v[128:143]
v_fma_f32 v10, -v218, v74, v10
v_fmac_f32 v14, v202, v74
v_mul_f32 v11, v203, v59
v_mul_f32 v15, v219, v59
v_fma_f32 v11, -v219, v75, v11
v_fmac_f32 v15, v203, v75
v_cvt_pk_bf16_f32 v180, v8, v9
v_cvt_pk_bf16_f32 v181, v10, v11
v_mfma_f32_32x32x16_bf16 v[144:159], v[116:119], v[36:39], v[144:159]
v_cvt_pk_bf16_f32 v188, v12, v13
v_cvt_pk_bf16_f32 v189, v14, v15
v_mul_f32 v8, v204, v60
v_mul_f32 v12, v220, v60
v_fma_f32 v8, -v220, v76, v8
v_fmac_f32 v12, v204, v76
v_mul_f32 v9, v205, v61
v_mul_f32 v13, v221, v61
v_fma_f32 v9, -v221, v77, v9
v_fmac_f32 v13, v205, v77
v_mul_f32 v10, v206, v62
v_mul_f32 v14, v222, v62
v_fma_f32 v10, -v222, v78, v10
v_fmac_f32 v14, v206, v78
v_mul_f32 v11, v207, v63
v_mul_f32 v15, v223, v63
v_fma_f32 v11, -v223, v79, v11
v_fmac_f32 v15, v207, v79
v_cvt_pk_bf16_f32 v182, v8, v9
v_cvt_pk_bf16_f32 v183, v10, v11
v_cvt_pk_bf16_f32 v190, v12, v13
v_cvt_pk_bf16_f32 v191, v14, v15
s_nop 1
v_mfma_f32_32x32x16_bf16 v[192:207], v[176:179], v[24:27], 0
v_mfma_f32_32x32x16_bf16 v[208:223], v[184:187], v[24:27], 0
v_mfma_f32_32x32x16_bf16 v[192:207], v[180:183], v[28:31], v[192:207]
v_mfma_f32_32x32x16_bf16 v[208:223], v[188:191], v[28:31], v[208:223]
v_mfma_f32_32x32x16_bf16 v[192:207], v[184:187], v[40:43], v[192:207]
v_mfma_f32_32x32x16_bf16 v[208:223], v[176:179], v[32:35], v[208:223]
v_mfma_f32_32x32x16_bf16 v[192:207], v[188:191], v[44:47], v[192:207]
v_mfma_f32_32x32x16_bf16 v[208:223], v[180:183], v[36:39], v[208:223]
s_nop 7
s_nop 3
v_pk_mul_f32 v[8:9], v[192:193], v[80:81]
v_pk_mul_f32 v[10:11], v[208:209], v[80:81]
v_pk_fma_f32 v[8:9], v[208:209], v[96:97], v[8:9] neg_lo:[1,0,0] neg_hi:[1,0,0]
v_pk_fma_f32 v[10:11], v[192:193], v[96:97], v[10:11]
v_pk_add_f32 v[192:193], v[128:129], v[8:9] neg_lo:[0,1] neg_hi:[0,1]
v_pk_add_f32 v[208:209], v[144:145], v[10:11] neg_lo:[0,1] neg_hi:[0,1]
v_pk_add_f32 v[128:129], v[128:129], v[8:9]
v_pk_add_f32 v[144:145], v[144:145], v[10:11]
v_pk_mul_f32 v[8:9], v[194:195], v[82:83]
v_pk_mul_f32 v[10:11], v[210:211], v[82:83]
v_pk_fma_f32 v[8:9], v[210:211], v[98:99], v[8:9] neg_lo:[1,0,0] neg_hi:[1,0,0]
v_pk_fma_f32 v[10:11], v[194:195], v[98:99], v[10:11]
v_pk_add_f32 v[194:195], v[130:131], v[8:9] neg_lo:[0,1] neg_hi:[0,1]
v_pk_add_f32 v[210:211], v[146:147], v[10:11] neg_lo:[0,1] neg_hi:[0,1]
v_pk_add_f32 v[130:131], v[130:131], v[8:9]
v_pk_add_f32 v[146:147], v[146:147], v[10:11]
v_pk_mul_f32 v[8:9], v[196:197], v[84:85]
v_pk_mul_f32 v[10:11], v[212:213], v[84:85]
v_pk_fma_f32 v[8:9], v[212:213], v[100:101], v[8:9] neg_lo:[1,0,0] neg_hi:[1,0,0]
v_pk_fma_f32 v[10:11], v[196:197], v[100:101], v[10:11]
v_pk_add_f32 v[196:197], v[132:133], v[8:9] neg_lo:[0,1] neg_hi:[0,1]
v_pk_add_f32 v[212:213], v[148:149], v[10:11] neg_lo:[0,1] neg_hi:[0,1]
v_pk_add_f32 v[132:133], v[132:133], v[8:9]
v_pk_add_f32 v[148:149], v[148:149], v[10:11]
v_pk_mul_f32 v[8:9], v[198:199], v[86:87]
v_pk_mul_f32 v[10:11], v[214:215], v[86:87]
v_pk_fma_f32 v[8:9], v[214:215], v[102:103], v[8:9] neg_lo:[1,0,0] neg_hi:[1,0,0]
v_pk_fma_f32 v[10:11], v[198:199], v[102:103], v[10:11]
v_pk_add_f32 v[198:199], v[134:135], v[8:9] neg_lo:[0,1] neg_hi:[0,1]
v_pk_add_f32 v[214:215], v[150:151], v[10:11] neg_lo:[0,1] neg_hi:[0,1]
v_pk_add_f32 v[134:135], v[134:135], v[8:9]
v_pk_add_f32 v[150:151], v[150:151], v[10:11]
v_pk_mul_f32 v[8:9], v[200:201], v[88:89]
v_pk_mul_f32 v[10:11], v[216:217], v[88:89]
v_pk_fma_f32 v[8:9], v[216:217], v[104:105], v[8:9] neg_lo:[1,0,0] neg_hi:[1,0,0]
v_pk_fma_f32 v[10:11], v[200:201], v[104:105], v[10:11]
v_pk_add_f32 v[200:201], v[136:137], v[8:9] neg_lo:[0,1] neg_hi:[0,1]
v_pk_add_f32 v[216:217], v[152:153], v[10:11] neg_lo:[0,1] neg_hi:[0,1]
v_pk_add_f32 v[136:137], v[136:137], v[8:9]
v_pk_add_f32 v[152:153], v[152:153], v[10:11]
v_pk_mul_f32 v[8:9], v[202:203], v[90:91]
v_pk_mul_f32 v[10:11], v[218:219], v[90:91]
v_pk_fma_f32 v[8:9], v[218:219], v[106:107], v[8:9] neg_lo:[1,0,0] neg_hi:[1,0,0]
v_pk_fma_f32 v[10:11], v[202:203], v[106:107], v[10:11]
v_pk_add_f32 v[202:203], v[138:139], v[8:9] neg_lo:[0,1] neg_hi:[0,1]
v_pk_add_f32 v[218:219], v[154:155], v[10:11] neg_lo:[0,1] neg_hi:[0,1]
v_pk_add_f32 v[138:139], v[138:139], v[8:9]
v_pk_add_f32 v[154:155], v[154:155], v[10:11]
v_pk_mul_f32 v[8:9], v[204:205], v[92:93]
v_pk_mul_f32 v[10:11], v[220:221], v[92:93]
v_pk_fma_f32 v[8:9], v[220:221], v[108:109], v[8:9] neg_lo:[1,0,0] neg_hi:[1,0,0]
v_pk_fma_f32 v[10:11], v[204:205], v[108:109], v[10:11]
v_pk_add_f32 v[204:205], v[140:141], v[8:9] neg_lo:[0,1] neg_hi:[0,1]
v_pk_add_f32 v[220:221], v[156:157], v[10:11] neg_lo:[0,1] neg_hi:[0,1]
v_pk_add_f32 v[140:141], v[140:141], v[8:9]
v_pk_add_f32 v[156:157], v[156:157], v[10:11]
v_pk_mul_f32 v[8:9], v[206:207], v[94:95]
v_pk_mul_f32 v[10:11], v[222:223], v[94:95]
v_pk_fma_f32 v[8:9], v[222:223], v[110:111], v[8:9] neg_lo:[1,0,0] neg_hi:[1,0,0]
v_pk_fma_f32 v[10:11], v[206:207], v[110:111], v[10:11]
v_pk_add_f32 v[206:207], v[142:143], v[8:9] neg_lo:[0,1] neg_hi:[0,1]
v_pk_add_f32 v[222:223], v[158:159], v[10:11] neg_lo:[0,1] neg_hi:[0,1]
v_pk_add_f32 v[142:143], v[142:143], v[8:9]
v_pk_add_f32 v[158:159], v[158:159], v[10:11]
s_movk_i32 s56, 0x1000
s_nop 1
v_permlane32_swap_b32 v128, v132
v_permlane32_swap_b32 v129, v133
v_permlane32_swap_b32 v130, v134
v_permlane32_swap_b32 v131, v135
v_permlane32_swap_b32 v136, v140
v_permlane32_swap_b32 v137, v141
v_permlane32_swap_b32 v138, v142
v_permlane32_swap_b32 v139, v143
v_cvt_pk_bf16_f32 v112, v128, v129
v_cvt_pk_bf16_f32 v113, v130, v131
v_cvt_pk_bf16_f32 v114, v132, v133
v_cvt_pk_bf16_f32 v115, v134, v135
v_cvt_pk_bf16_f32 v116, v136, v137
v_cvt_pk_bf16_f32 v117, v138, v139
v_cvt_pk_bf16_f32 v118, v140, v141
v_cvt_pk_bf16_f32 v119, v142, v143
s_nop 1
v_permlane16_swap_b32 v112, v116
v_permlane16_swap_b32 v113, v117
v_permlane16_swap_b32 v114, v118
v_permlane16_swap_b32 v115, v119
buffer_store_dwordx4 v[112:115], v6, s[44:47], 0 offen offset:0 sc1
buffer_store_dwordx4 v[116:119], v6, s[44:47], 0 offen offset:1024 sc1
s_nop 1
v_permlane32_swap_b32 v192, v196
v_permlane32_swap_b32 v193, v197
v_permlane32_swap_b32 v194, v198
v_permlane32_swap_b32 v195, v199
v_permlane32_swap_b32 v200, v204
v_permlane32_swap_b32 v201, v205
v_permlane32_swap_b32 v202, v206
v_permlane32_swap_b32 v203, v207
v_cvt_pk_bf16_f32 v120, v192, v193
v_cvt_pk_bf16_f32 v121, v194, v195
v_cvt_pk_bf16_f32 v122, v196, v197
v_cvt_pk_bf16_f32 v123, v198, v199
v_cvt_pk_bf16_f32 v124, v200, v201
v_cvt_pk_bf16_f32 v125, v202, v203
v_cvt_pk_bf16_f32 v126, v204, v205
v_cvt_pk_bf16_f32 v127, v206, v207
s_nop 1
v_permlane16_swap_b32 v120, v124
v_permlane16_swap_b32 v121, v125
v_permlane16_swap_b32 v122, v126
v_permlane16_swap_b32 v123, v127
buffer_store_dwordx4 v[120:123], v6, s[44:47], 0 offen offset:2048 sc1
buffer_store_dwordx4 v[124:127], v6, s[44:47], 0 offen offset:3072 sc1
s_nop 1
v_permlane32_swap_b32 v144, v148
v_permlane32_swap_b32 v145, v149
v_permlane32_swap_b32 v146, v150
v_permlane32_swap_b32 v147, v151
v_permlane32_swap_b32 v152, v156
v_permlane32_swap_b32 v153, v157
v_permlane32_swap_b32 v154, v158
v_permlane32_swap_b32 v155, v159
v_cvt_pk_bf16_f32 v176, v144, v145
v_cvt_pk_bf16_f32 v177, v146, v147
v_cvt_pk_bf16_f32 v178, v148, v149
v_cvt_pk_bf16_f32 v179, v150, v151
v_cvt_pk_bf16_f32 v180, v152, v153
v_cvt_pk_bf16_f32 v181, v154, v155
v_cvt_pk_bf16_f32 v182, v156, v157
v_cvt_pk_bf16_f32 v183, v158, v159
s_nop 1
v_permlane16_swap_b32 v176, v180
v_permlane16_swap_b32 v177, v181
v_permlane16_swap_b32 v178, v182
v_permlane16_swap_b32 v179, v183
buffer_store_dwordx4 v[176:179], v6, s[44:47], s56 offen offset:0 sc1
buffer_store_dwordx4 v[180:183], v6, s[44:47], s56 offen offset:1024 sc1
s_nop 1
v_permlane32_swap_b32 v208, v212
v_permlane32_swap_b32 v209, v213
v_permlane32_swap_b32 v210, v214
v_permlane32_swap_b32 v211, v215
v_permlane32_swap_b32 v216, v220
v_permlane32_swap_b32 v217, v221
v_permlane32_swap_b32 v218, v222
v_permlane32_swap_b32 v219, v223
v_cvt_pk_bf16_f32 v184, v208, v209
v_cvt_pk_bf16_f32 v185, v210, v211
v_cvt_pk_bf16_f32 v186, v212, v213
v_cvt_pk_bf16_f32 v187, v214, v215
v_cvt_pk_bf16_f32 v188, v216, v217
v_cvt_pk_bf16_f32 v189, v218, v219
v_cvt_pk_bf16_f32 v190, v220, v221
v_cvt_pk_bf16_f32 v191, v222, v223
s_nop 1
v_permlane16_swap_b32 v184, v188
v_permlane16_swap_b32 v185, v189
v_permlane16_swap_b32 v186, v190
v_permlane16_swap_b32 v187, v191
buffer_store_dwordx4 v[184:187], v6, s[44:47], s56 offen offset:2048 sc1
buffer_store_dwordx4 v[188:191], v6, s[44:47], s56 offen offset:3072 sc1
v_xor_b32 v3, 64, v3
v_xor_b32 v5, 64, v5
v_add_u32 v6, 32768, v6
s_add_u32 s64, s64, 4
s_add_u32 s65, s65, 1
s_cmp_lt_u32 s65, 2
s_cbranch_scc1 L_fftcol_19
s_waitcnt vmcnt(0)
s_barrier
s_cmp_lg_u32 s3, 0
s_cbranch_scc1 L_pub_24
s_lshl_b32 s56, s33, 7
s_add_u32 s56, s56, 9043968
s_mov_b64 exec, 1
v_mov_b32 v8, s26
v_mov_b32 v9, s56
global_store_dword v9, v8, s[24:25] sc1
s_mov_b64 exec, -1
L_pub_24:
v_and_b32 v1, 63, v0
v_lshrrev_b32 v44, 5, v1
v_lshlrev_b32 v44, 3, v44
v_bfe_u32 v45, v1, 2, 2
v_add_u32 v44, v44, v45
v_lshlrev_b32 v44, 7, v44
v_bfe_u32 v46, v1, 4, 1
v_lshlrev_b32 v46, 5, v46
v_and_b32 v47, 3, v1
v_lshl_add_u32 v46, v47, 3, v46
v_lshlrev_b32 v45, 5, v45
v_and_b32 v45, 64, v45
v_or_b32 v46, v46, v45
v_add3_u32 v44, v44, v46, s29
s_lshl_b32 s56, s3, 6
s_and_b32 s56, s56, 64
v_xor_b32 v6, s56, v44
v_xor_b32 v7, 64, v6
s_lshl_b32 s56, s3, 5
s_and_b32 s56, s56, 64
v_xor_b32 v8, s56, v44
v_xor_b32 v9, 64, v8
s_add_u32 s36, s24, 2097152
s_addc_u32 s37, s25, 0
s_mov_b32 s38, 1835008
s_mov_b32 s39, 0x20000
s_lshl_b32 s57, s30, 7
v_lshrrev_b32 v44, 3, v1
v_and_b32 v45, 7, v1
v_lshlrev_b32 v46, 1, v44
v_and_b32 v46, 4, v46
v_xor_b32 v45, v45, v46
v_lshlrev_b32 v45, 4, v45
s_mov_b32 s56, 1024
v_mad_u32_u24 v2, v44, s56, v45
v_add_u32 v2, s57, v2
v_add_u32 v3, 7168, v2
s_mul_i32 s52, s3, 16384
s_lshl_b32 s56, s95, 16
s_add_u32 s52, s52, s56
s_add_u32 s44, s24, 9437184
s_addc_u32 s45, s25, 0
s_mov_b32 s46, 2097152
s_mov_b32 s47, 0x20000
s_lshl_b32 s57, s32, 7
v_lshrrev_b32 v44, 3, v1
v_and_b32 v45, 7, v1
v_lshlrev_b32 v46, 1, v44
v_and_b32 v46, 4, v46
v_xor_b32 v45, v45, v46
v_lshlrev_b32 v45, 4, v45
s_mov_b32 s56, 4096
v_mad_u32_u24 v4, v44, s56, v45
v_add_u32 v4, s57, v4
v_add_u32 v5, 31744, v4
s_mul_i32 s97, s3, 65536
s_lshl_b32 s56, s96, 18
s_add_u32 s97, s97, s56
s_lshr_b32 s56, s3, 1
s_lshl_b32 s56, s56, 5
s_lshl_b32 s57, s32, 6
s_add_u32 s56, s56, s57
v_and_b32 v44, 31, v1
v_add_u32 v44, s56, v44
s_and_b32 s56, s3, 1
s_lshl_b32 s56, s56, 6
s_lshl_b32 s57, s30, 7
s_add_u32 s56, s56, s57
v_lshrrev_b32 v45, 5, v1
v_lshlrev_b32 v45, 4, v45
v_lshl_add_u32 v50, v44, 10, v45
v_add_u32 v50, s56, v50
v_lshrrev_b32 v45, 9, v50
v_and_b32 v45, 0xfffffffe, v45
global_load_ushort v176, v45, s[18:19]
global_load_dwordx4 v[168:171], v50, s[4:5]
global_load_dwordx4 v[172:175], v50, s[4:5] offset:32
v_lshrrev_b32 v49, 9, v50
v_and_b32 v49, 0xfffffffe, v49
v_add_u32 v49, 9441280, v49
v_min_u32 v63, 31, v1
v_lshlrev_b32 v63, 7, v63
v_add_u32 v63, 9043968, v63
s_and_b32 s62, s3, 1
s_lshl_b32 s62, s62, 5
s_lshl_b32 s63, s30, 6
s_add_u32 s62, s62, s63
v_and_b32 v36, 31, v1
v_add_u32 v36, s62, v36
v_xor_b32 v37, 32, v36
v_cvt_f32_u32 v36, v36
v_cvt_f32_u32 v37, v37
v_mul_f32 v36, 0x3b000000, v36
v_mul_f32 v37, 0x3b000000, v37
v_lshrrev_b32 v38, 5, v1
v_lshlrev_b32 v38, 2, v38
s_lshl_b32 s62, s3, 3
v_add_u32 v38, s62, v38
s_add_u32 s63, s96, 0
s_and_b32 s63, s63, 7
s_lshl_b32 s62, s63, 5
v_add_u32 v39, s62, v38
v_cvt_f32_u32 v39, v39
s_add_u32 s63, s63, 1
s_and_b32 s63, s63, 7
v_mul_f32 v40, v39, v36
v_mul_f32 v41, v39, v37
v_sin_f32 v42, v40
v_sin_f32 v43, v41
v_cos_f32 v40, v40
v_cos_f32 v41, v41
v_add_f32 v39, 1.0, v39
v_cvt_pk_bf16_f32 v192, v40, -v42
v_cvt_pk_bf16_f32 v196, v41, -v43
v_mul_f32 v40, v39, v36
v_mul_f32 v41, v39, v37
v_sin_f32 v42, v40
v_sin_f32 v43, v41
v_cos_f32 v40, v40
v_cos_f32 v41, v41
v_add_f32 v39, 1.0, v39
v_cvt_pk_bf16_f32 v193, v40, -v42
v_cvt_pk_bf16_f32 v197, v41, -v43
v_mul_f32 v40, v39, v36
v_mul_f32 v41, v39, v37
v_sin_f32 v42, v40
v_sin_f32 v43, v41
v_cos_f32 v40, v40
v_cos_f32 v41, v41
v_add_f32 v39, 1.0, v39
v_cvt_pk_bf16_f32 v194, v40, -v42
v_cvt_pk_bf16_f32 v198, v41, -v43
v_mul_f32 v40, v39, v36
v_mul_f32 v41, v39, v37
v_sin_f32 v42, v40
v_sin_f32 v43, v41
v_cos_f32 v40, v40
v_cos_f32 v41, v41
v_add_f32 v39, 1.0, v39
v_cvt_pk_bf16_f32 v195, v40, -v42
v_cvt_pk_bf16_f32 v199, v41, -v43
s_lshl_b32 s62, s63, 5
v_add_u32 v39, s62, v38
v_cvt_f32_u32 v39, v39
s_add_u32 s63, s63, 1
s_and_b32 s63, s63, 7
v_mul_f32 v40, v39, v36
v_mul_f32 v41, v39, v37
v_sin_f32 v42, v40
v_sin_f32 v43, v41
v_cos_f32 v40, v40
v_cos_f32 v41, v41
v_add_f32 v39, 1.0, v39
v_cvt_pk_bf16_f32 v200, v40, -v42
v_cvt_pk_bf16_f32 v204, v41, -v43
v_mul_f32 v40, v39, v36
v_mul_f32 v41, v39, v37
v_sin_f32 v42, v40
v_sin_f32 v43, v41
v_cos_f32 v40, v40
v_cos_f32 v41, v41
v_add_f32 v39, 1.0, v39
v_cvt_pk_bf16_f32 v201, v40, -v42
v_cvt_pk_bf16_f32 v205, v41, -v43
v_mul_f32 v40, v39, v36
v_mul_f32 v41, v39, v37
v_sin_f32 v42, v40
v_sin_f32 v43, v41
v_cos_f32 v40, v40
v_cos_f32 v41, v41
v_add_f32 v39, 1.0, v39
v_cvt_pk_bf16_f32 v202, v40, -v42
v_cvt_pk_bf16_f32 v206, v41, -v43
v_mul_f32 v40, v39, v36
v_mul_f32 v41, v39, v37
v_sin_f32 v42, v40
v_sin_f32 v43, v41
v_cos_f32 v40, v40
v_cos_f32 v41, v41
v_add_f32 v39, 1.0, v39
v_cvt_pk_bf16_f32 v203, v40, -v42
v_cvt_pk_bf16_f32 v207, v41, -v43
s_lshl_b32 s62, s63, 5
v_add_u32 v39, s62, v38
v_cvt_f32_u32 v39, v39
s_add_u32 s63, s63, 1
s_and_b32 s63, s63, 7
v_mul_f32 v40, v39, v36
v_mul_f32 v41, v39, v37
v_sin_f32 v42, v40
v_sin_f32 v43, v41
v_cos_f32 v40, v40
v_cos_f32 v41, v41
v_add_f32 v39, 1.0, v39
v_cvt_pk_bf16_f32 v208, v40, -v42
v_cvt_pk_bf16_f32 v212, v41, -v43
v_mul_f32 v40, v39, v36
v_mul_f32 v41, v39, v37
v_sin_f32 v42, v40
v_sin_f32 v43, v41
v_cos_f32 v40, v40
v_cos_f32 v41, v41
v_add_f32 v39, 1.0, v39
v_cvt_pk_bf16_f32 v209, v40, -v42
v_cvt_pk_bf16_f32 v213, v41, -v43
v_mul_f32 v40, v39, v36
v_mul_f32 v41, v39, v37
v_sin_f32 v42, v40
v_sin_f32 v43, v41
v_cos_f32 v40, v40
v_cos_f32 v41, v41
v_add_f32 v39, 1.0, v39
v_cvt_pk_bf16_f32 v210, v40, -v42
v_cvt_pk_bf16_f32 v214, v41, -v43
v_mul_f32 v40, v39, v36
v_mul_f32 v41, v39, v37
v_sin_f32 v42, v40
v_sin_f32 v43, v41
v_cos_f32 v40, v40
v_cos_f32 v41, v41
v_add_f32 v39, 1.0, v39
v_cvt_pk_bf16_f32 v211, v40, -v42
v_cvt_pk_bf16_f32 v215, v41, -v43
s_lshl_b32 s62, s63, 5
v_add_u32 v39, s62, v38
v_cvt_f32_u32 v39, v39
s_add_u32 s63, s63, 1
s_and_b32 s63, s63, 7
v_mul_f32 v40, v39, v36
v_mul_f32 v41, v39, v37
v_sin_f32 v42, v40
v_sin_f32 v43, v41
v_cos_f32 v40, v40
v_cos_f32 v41, v41
v_add_f32 v39, 1.0, v39
v_cvt_pk_bf16_f32 v216, v40, -v42
v_cvt_pk_bf16_f32 v220, v41, -v43
v_mul_f32 v40, v39, v36
v_mul_f32 v41, v39, v37
v_sin_f32 v42, v40
v_sin_f32 v43, v41
v_cos_f32 v40, v40
v_cos_f32 v41, v41
v_add_f32 v39, 1.0, v39
v_cvt_pk_bf16_f32 v217, v40, -v42
v_cvt_pk_bf16_f32 v221, v41, -v43
v_mul_f32 v40, v39, v36
v_mul_f32 v41, v39, v37
v_sin_f32 v42, v40
v_sin_f32 v43, v41
v_cos_f32 v40, v40
v_cos_f32 v41, v41
v_add_f32 v39, 1.0, v39
v_cvt_pk_bf16_f32 v218, v40, -v42
v_cvt_pk_bf16_f32 v222, v41, -v43
v_mul_f32 v40, v39, v36
v_mul_f32 v41, v39, v37
v_sin_f32 v42, v40
v_sin_f32 v43, v41
v_cos_f32 v40, v40
v_cos_f32 v41, v41
v_add_f32 v39, 1.0, v39
v_cvt_pk_bf16_f32 v219, v40, -v42
v_cvt_pk_bf16_f32 v223, v41, -v43
L_p3_3:
v_min_u32 v128, 27, v1
v_lshlrev_b32 v128, 7, v128
s_lshl_b32 s56, s30, 12
s_add_u32 s56, s56, 9011200
v_add_u32 v128, s56, v128
s_mov_b32 s57, 0
L_wp_26:
global_load_dword v129, v128, s[24:25] sc1
s_waitcnt vmcnt(0)
v_cmp_eq_u32 vcc, s26, v129
s_nop 4
s_cmp_eq_u64 vcc, -1
s_cbranch_scc1 L_wp_ok_25
s_add_u32 s57, s57, 1
s_cmp_lt_u32 s57, 262144
s_cbranch_scc1 L_wp_26
L_wp_ok_25:
s_add_u32 m0, s29, 0
s_nop 0
buffer_load_dwordx4 v2, s[36:39], s52 offen  lds
buffer_load_dwordx4 v3, s[36:39], s52 offen offset:1024  lds
s_add_u32 s52, s52, 65536
s_cmp_ge_u32 s52, 1835008
s_cselect_b32 s93, 1835008, 0
s_sub_u32 s52, s52, s93
s_add_u32 m0, s29, 2048
s_nop 0
buffer_load_dwordx4 v2, s[36:39], s52 offen  lds
buffer_load_dwordx4 v3, s[36:39], s52 offen offset:1024  lds
s_add_u32 s52, s52, 65536
s_cmp_ge_u32 s52, 1835008
s_cselect_b32 s93, 1835008, 0
s_sub_u32 s52, s52, s93
s_add_u32 m0, s29, 4096
s_nop 0
buffer_load_dwordx4 v2, s[36:39], s52 offen  lds
buffer_load_dwordx4 v3, s[36:39], s52 offen offset:1024  lds
s_add_u32 s52, s52, 65536
s_cmp_ge_u32 s52, 1835008
s_cselect_b32 s93, 1835008, 0
s_sub_u32 s52, s52, s93
s_add_u32 m0, s29, 6144
s_nop 0
buffer_load_dwordx4 v2, s[36:39], s52 offen  lds
buffer_load_dwordx4 v3, s[36:39], s52 offen offset:1024  lds
s_add_u32 s52, s52, 65536
s_cmp_ge_u32 s52, 1835008
s_cselect_b32 s93, 1835008, 0
s_sub_u32 s52, s52, s93
s_and_b32 s62, s3, 1
s_lshl_b32 s62, s62, 5
s_lshl_b32 s63, s30, 6
s_add_u32 s62, s62, s63
v_and_b32 v36, 31, v1
v_add_u32 v36, s62, v36
v_xor_b32 v37, 32, v36
v_cvt_f32_u32 v36, v36
v_cvt_f32_u32 v37, v37
v_mul_f32 v36, 0x3b000000, v36
v_mul_f32 v37, 0x3b000000, v37
v_lshrrev_b32 v38, 5, v1
v_lshlrev_b32 v38, 2, v38
s_lshl_b32 s62, s3, 3
v_add_u32 v38, s62, v38
s_add_u32 s63, s96, 4
s_and_b32 s63, s63, 7
s_lshl_b32 s62, s63, 5
v_add_u32 v39, s62, v38
v_cvt_f32_u32 v39, v39
s_add_u32 s63, s63, 1
s_and_b32 s63, s63, 7
v_mul_f32 v40, v39, v36
v_mul_f32 v41, v39, v37
v_sin_f32 v42, v40
v_sin_f32 v43, v41
v_cos_f32 v40, v40
v_cos_f32 v41, v41
v_add_f32 v39, 1.0, v39
v_cvt_pk_bf16_f32 v224, v40, -v42
v_cvt_pk_bf16_f32 v228, v41, -v43
v_mul_f32 v40, v39, v36
v_mul_f32 v41, v39, v37
v_sin_f32 v42, v40
v_sin_f32 v43, v41
v_cos_f32 v40, v40
v_cos_f32 v41, v41
v_add_f32 v39, 1.0, v39
v_cvt_pk_bf16_f32 v225, v40, -v42
v_cvt_pk_bf16_f32 v229, v41, -v43
v_mul_f32 v40, v39, v36
v_mul_f32 v41, v39, v37
v_sin_f32 v42, v40
v_sin_f32 v43, v41
v_cos_f32 v40, v40
v_cos_f32 v41, v41
v_add_f32 v39, 1.0, v39
v_cvt_pk_bf16_f32 v226, v40, -v42
v_cvt_pk_bf16_f32 v230, v41, -v43
v_mul_f32 v40, v39, v36
v_mul_f32 v41, v39, v37
v_sin_f32 v42, v40
v_sin_f32 v43, v41
v_cos_f32 v40, v40
v_cos_f32 v41, v41
v_add_f32 v39, 1.0, v39
v_cvt_pk_bf16_f32 v227, v40, -v42
v_cvt_pk_bf16_f32 v231, v41, -v43
s_lshl_b32 s62, s63, 5
v_add_u32 v39, s62, v38
v_cvt_f32_u32 v39, v39
s_add_u32 s63, s63, 1
s_and_b32 s63, s63, 7
v_mul_f32 v40, v39, v36
v_mul_f32 v41, v39, v37
v_sin_f32 v42, v40
v_sin_f32 v43, v41
v_cos_f32 v40, v40
v_cos_f32 v41, v41
v_add_f32 v39, 1.0, v39
v_cvt_pk_bf16_f32 v232, v40, -v42
v_cvt_pk_bf16_f32 v236, v41, -v43
v_mul_f32 v40, v39, v36
v_mul_f32 v41, v39, v37
v_sin_f32 v42, v40
v_sin_f32 v43, v41
v_cos_f32 v40, v40
v_cos_f32 v41, v41
v_add_f32 v39, 1.0, v39
v_cvt_pk_bf16_f32 v233, v40, -v42
v_cvt_pk_bf16_f32 v237, v41, -v43
v_mul_f32 v40, v39, v36
v_mul_f32 v41, v39, v37
v_sin_f32 v42, v40
v_sin_f32 v43, v41
v_cos_f32 v40, v40
v_cos_f32 v41, v41
v_add_f32 v39, 1.0, v39
v_cvt_pk_bf16_f32 v234, v40, -v42
v_cvt_pk_bf16_f32 v238, v41, -v43
v_mul_f32 v40, v39, v36
v_mul_f32 v41, v39, v37
v_sin_f32 v42, v40
v_sin_f32 v43, v41
v_cos_f32 v40, v40
v_cos_f32 v41, v41
v_add_f32 v39, 1.0, v39
v_cvt_pk_bf16_f32 v235, v40, -v42
v_cvt_pk_bf16_f32 v239, v41, -v43
s_lshl_b32 s62, s63, 5
v_add_u32 v39, s62, v38
v_cvt_f32_u32 v39, v39
s_add_u32 s63, s63, 1
s_and_b32 s63, s63, 7
v_mul_f32 v40, v39, v36
v_mul_f32 v41, v39, v37
v_sin_f32 v42, v40
v_sin_f32 v43, v41
v_cos_f32 v40, v40
v_cos_f32 v41, v41
v_add_f32 v39, 1.0, v39
v_cvt_pk_bf16_f32 v240, v40, -v42
v_cvt_pk_bf16_f32 v244, v41, -v43
v_mul_f32 v40, v39, v36
v_mul_f32 v41, v39, v37
v_sin_f32 v42, v40
v_sin_f32 v43, v41
v_cos_f32 v40, v40
v_cos_f32 v41, v41
v_add_f32 v39, 1.0, v39
v_cvt_pk_bf16_f32 v241, v40, -v42
v_cvt_pk_bf16_f32 v245, v41, -v43
v_mul_f32 v40, v39, v36
v_mul_f32 v41, v39, v37
v_sin_f32 v42, v40
v_sin_f32 v43, v41
v_cos_f32 v40, v40
v_cos_f32 v41, v41
v_add_f32 v39, 1.0, v39
v_cvt_pk_bf16_f32 v242, v40, -v42
v_cvt_pk_bf16_f32 v246, v41, -v43
v_mul_f32 v40, v39, v36
v_mul_f32 v41, v39, v37
v_sin_f32 v42, v40
v_sin_f32 v43, v41
v_cos_f32 v40, v40
v_cos_f32 v41, v41
v_add_f32 v39, 1.0, v39
v_cvt_pk_bf16_f32 v243, v40, -v42
v_cvt_pk_bf16_f32 v247, v41, -v43
s_lshl_b32 s62, s63, 5
v_add_u32 v39, s62, v38
v_cvt_f32_u32 v39, v39
s_add_u32 s63, s63, 1
s_and_b32 s63, s63, 7
v_mul_f32 v40, v39, v36
v_mul_f32 v41, v39, v37
v_sin_f32 v42, v40
v_sin_f32 v43, v41
v_cos_f32 v40, v40
v_cos_f32 v41, v41
v_add_f32 v39, 1.0, v39
v_cvt_pk_bf16_f32 v248, v40, -v42
v_cvt_pk_bf16_f32 v252, v41, -v43
v_mul_f32 v40, v39, v36
v_mul_f32 v41, v39, v37
v_sin_f32 v42, v40
v_sin_f32 v43, v41
v_cos_f32 v40, v40
v_cos_f32 v41, v41
v_add_f32 v39, 1.0, v39
v_cvt_pk_bf16_f32 v249, v40, -v42
v_cvt_pk_bf16_f32 v253, v41, -v43
v_mul_f32 v40, v39, v36
v_mul_f32 v41, v39, v37
v_sin_f32 v42, v40
v_sin_f32 v43, v41
v_cos_f32 v40, v40
v_cos_f32 v41, v41
v_add_f32 v39, 1.0, v39
v_cvt_pk_bf16_f32 v250, v40, -v42
v_cvt_pk_bf16_f32 v254, v41, -v43
v_mul_f32 v40, v39, v36
v_mul_f32 v41, v39, v37
v_sin_f32 v42, v40
v_sin_f32 v43, v41
v_cos_f32 v40, v40
v_cos_f32 v41, v41
v_add_f32 v39, 1.0, v39
v_cvt_pk_bf16_f32 v251, v40, -v42
v_cvt_pk_bf16_f32 v255, v41, -v43
s_add_u32 m0, s29, 8192
s_nop 0
buffer_load_dwordx4 v2, s[36:39], s52 offen  lds
buffer_load_dwordx4 v3, s[36:39], s52 offen offset:1024  lds
s_add_u32 s52, s52, 65536
s_cmp_ge_u32 s52, 1835008
s_cselect_b32 s93, 1835008, 0
s_sub_u32 s52, s52, s93
s_add_u32 m0, s29, 10240
s_nop 0
buffer_load_dwordx4 v2, s[36:39], s52 offen  lds
buffer_load_dwordx4 v3, s[36:39], s52 offen offset:1024  lds
s_add_u32 s52, s52, 65536
s_cmp_ge_u32 s52, 1835008
s_cselect_b32 s93, 1835008, 0
s_sub_u32 s52, s52, s93
s_add_u32 m0, s29, 12288
s_nop 0
buffer_load_dwordx4 v2, s[36:39], s52 offen  lds
buffer_load_dwordx4 v3, s[36:39], s52 offen offset:1024  lds
s_add_u32 s52, s52, 65536
s_cmp_ge_u32 s52, 1835008
s_cselect_b32 s93, 1835008, 0
s_sub_u32 s52, s52, s93
s_add_u32 m0, s29, 14336
s_nop 0
buffer_load_dwordx4 v2, s[36:39], s52 offen  lds
buffer_load_dwordx4 v3, s[36:39], s52 offen offset:1024  lds
s_add_u32 s52, s52, 65536
s_cmp_ge_u32 s52, 1835008
s_cselect_b32 s93, 1835008, 0
s_sub_u32 s52, s52, s93
s_waitcnt vmcnt(14)
ds_read_b64_tr_b16 v[12:13], v6 offset:0
ds_read_b64_tr_b16 v[14:15], v6 offset:512
ds_read_b64_tr_b16 v[16:17], v7 offset:0
ds_read_b64_tr_b16 v[18:19], v7 offset:512
s_waitcnt vmcnt(12)
ds_read_b64_tr_b16 v[20:21], v6 offset:2048
ds_read_b64_tr_b16 v[22:23], v6 offset:2560
ds_read_b64_tr_b16 v[24:25], v7 offset:2048
ds_read_b64_tr_b16 v[26:27], v7 offset:2560
s_waitcnt lgkmcnt(4)
v_mfma_f32_32x32x16_bf16 v[64:79], v[12:15], a[0:3], 0
s_add_u32 m0, s29, 16384
s_nop 0
buffer_load_dwordx4 v2, s[36:39], s52 offen  lds
v_mfma_f32_32x32x16_bf16 v[80:95], v[16:19], a[0:3], 0
buffer_load_dwordx4 v3, s[36:39], s52 offen offset:1024  lds
s_add_u32 s52, s52, 65536
s_cmp_ge_u32 s52, 1835008
s_cselect_b32 s93, 1835008, 0
s_sub_u32 s52, s52, s93
s_waitcnt vmcnt(12)
v_mfma_f32_32x32x16_bf16 v[96:111], v[12:15], a[4:7], 0
ds_read_b64_tr_b16 v[28:29], v6 offset:4096
ds_read_b64_tr_b16 v[30:31], v6 offset:4608
v_mfma_f32_32x32x16_bf16 v[112:127], v[16:19], a[4:7], 0
ds_read_b64_tr_b16 v[32:33], v7 offset:4096
ds_read_b64_tr_b16 v[34:35], v7 offset:4608
s_waitcnt lgkmcnt(4)
v_mfma_f32_32x32x16_bf16 v[64:79], v[20:23], a[8:11], v[64:79]
s_add_u32 m0, s29, 18432
s_nop 0
buffer_load_dwordx4 v2, s[36:39], s52 offen  lds
v_mfma_f32_32x32x16_bf16 v[80:95], v[24:27], a[8:11], v[80:95]
buffer_load_dwordx4 v3, s[36:39], s52 offen offset:1024  lds
s_add_u32 s52, s52, 65536
s_cmp_ge_u32 s52, 1835008
s_cselect_b32 s93, 1835008, 0
s_sub_u32 s52, s52, s93
s_waitcnt vmcnt(12)
v_mfma_f32_32x32x16_bf16 v[96:111], v[20:23], a[12:15], v[96:111]
ds_read_b64_tr_b16 v[12:13], v6 offset:6144
ds_read_b64_tr_b16 v[14:15], v6 offset:6656
v_mfma_f32_32x32x16_bf16 v[112:127], v[24:27], a[12:15], v[112:127]
ds_read_b64_tr_b16 v[16:17], v7 offset:6144
ds_read_b64_tr_b16 v[18:19], v7 offset:6656
s_waitcnt lgkmcnt(4)
v_mfma_f32_32x32x16_bf16 v[64:79], v[28:31], a[16:19], v[64:79]
s_add_u32 m0, s29, 20480
s_nop 0
buffer_load_dwordx4 v2, s[36:39], s52 offen  lds
v_mfma_f32_32x32x16_bf16 v[80:95], v[32:35], a[16:19], v[80:95]
buffer_load_dwordx4 v3, s[36:39], s52 offen offset:1024  lds
s_add_u32 s52, s52, 65536
s_cmp_ge_u32 s52, 1835008
s_cselect_b32 s93, 1835008, 0
s_sub_u32 s52, s52, s93
s_waitcnt vmcnt(12)
v_mfma_f32_32x32x16_bf16 v[96:111], v[28:31], a[20:23], v[96:111]
ds_read_b64_tr_b16 v[20:21], v6 offset:8192
ds_read_b64_tr_b16 v[22:23], v6 offset:8704
v_mfma_f32_32x32x16_bf16 v[112:127], v[32:35], a[20:23], v[112:127]
ds_read_b64_tr_b16 v[24:25], v7 offset:8192
ds_read_b64_tr_b16 v[26:27], v7 offset:8704
s_waitcnt lgkmcnt(4)
v_mfma_f32_32x32x16_bf16 v[64:79], v[12:15], a[24:27], v[64:79]
s_add_u32 m0, s29, 22528
s_nop 0
buffer_load_dwordx4 v2, s[36:39], s52 offen  lds
v_mfma_f32_32x32x16_bf16 v[80:95], v[16:19], a[24:27], v[80:95]
buffer_load_dwordx4 v3, s[36:39], s52 offen offset:1024  lds
s_add_u32 s52, s52, 65536
s_cmp_ge_u32 s52, 1835008
s_cselect_b32 s93, 1835008, 0
s_sub_u32 s52, s52, s93
s_waitcnt vmcnt(12)
v_mfma_f32_32x32x16_bf16 v[96:111], v[12:15], a[28:31], v[96:111]
ds_read_b64_tr_b16 v[28:29], v6 offset:10240
ds_read_b64_tr_b16 v[30:31], v6 offset:10752
v_mfma_f32_32x32x16_bf16 v[112:127], v[16:19], a[28:31], v[112:127]
ds_read_b64_tr_b16 v[32:33], v7 offset:10240
ds_read_b64_tr_b16 v[34:35], v7 offset:10752
s_waitcnt lgkmcnt(4)
v_mfma_f32_32x32x16_bf16 v[64:79], v[20:23], a[32:35], v[64:79]
s_add_u32 m0, s29, 24576
s_nop 0
buffer_load_dwordx4 v2, s[36:39], s52 offen  lds
v_mfma_f32_32x32x16_bf16 v[80:95], v[24:27], a[32:35], v[80:95]
buffer_load_dwordx4 v3, s[36:39], s52 offen offset:1024  lds
s_add_u32 s52, s52, 65536
s_cmp_ge_u32 s52, 1835008
s_cselect_b32 s93, 1835008, 0
s_sub_u32 s52, s52, s93
s_waitcnt vmcnt(12)
v_mfma_f32_32x32x16_bf16 v[96:111], v[20:23], a[36:39], v[96:111]
ds_read_b64_tr_b16 v[12:13], v6 offset:12288
ds_read_b64_tr_b16 v[14:15], v6 offset:12800
v_mfma_f32_32x32x16_bf16 v[112:127], v[24:27], a[36:39], v[112:127]
ds_read_b64_tr_b16 v[16:17], v7 offset:12288
ds_read_b64_tr_b16 v[18:19], v7 offset:12800
s_waitcnt lgkmcnt(4)
v_mfma_f32_32x32x16_bf16 v[64:79], v[28:31], a[40:43], v[64:79]
s_add_u32 m0, s29, 26624
s_nop 0
buffer_load_dwordx4 v2, s[36:39], s52 offen  lds
v_mfma_f32_32x32x16_bf16 v[80:95], v[32:35], a[40:43], v[80:95]
buffer_load_dwordx4 v3, s[36:39], s52 offen offset:1024  lds
s_add_u32 s52, s52, 65536
s_cmp_ge_u32 s52, 1835008
s_cselect_b32 s93, 1835008, 0
s_sub_u32 s52, s52, s93
s_waitcnt vmcnt(12)
v_mfma_f32_32x32x16_bf16 v[96:111], v[28:31], a[44:47], v[96:111]
ds_read_b64_tr_b16 v[20:21], v6 offset:14336
ds_read_b64_tr_b16 v[22:23], v6 offset:14848
v_mfma_f32_32x32x16_bf16 v[112:127], v[32:35], a[44:47], v[112:127]
ds_read_b64_tr_b16 v[24:25], v7 offset:14336
ds_read_b64_tr_b16 v[26:27], v7 offset:14848
s_waitcnt lgkmcnt(4)
v_mfma_f32_32x32x16_bf16 v[64:79], v[12:15], a[48:51], v[64:79]
s_add_u32 m0, s29, 28672
s_nop 0
buffer_load_dwordx4 v2, s[36:39], s52 offen  lds
v_mfma_f32_32x32x16_bf16 v[80:95], v[16:19], a[48:51], v[80:95]
buffer_load_dwordx4 v3, s[36:39], s52 offen offset:1024  lds
s_add_u32 s52, s52, 65536
s_cmp_ge_u32 s52, 1835008
s_cselect_b32 s93, 1835008, 0
s_sub_u32 s52, s52, s93
s_waitcnt vmcnt(12)
v_mfma_f32_32x32x16_bf16 v[96:111], v[12:15], a[52:55], v[96:111]
ds_read_b64_tr_b16 v[28:29], v6 offset:16384
ds_read_b64_tr_b16 v[30:31], v6 offset:16896
v_mfma_f32_32x32x16_bf16 v[112:127], v[16:19], a[52:55], v[112:127]
ds_read_b64_tr_b16 v[32:33], v7 offset:16384
ds_read_b64_tr_b16 v[34:35], v7 offset:16896
s_waitcnt lgkmcnt(4)
v_mfma_f32_32x32x16_bf16 v[64:79], v[20:23], a[56:59], v[64:79]
s_add_u32 m0, s29, 30720
s_nop 0
buffer_load_dwordx4 v2, s[36:39], s52 offen  lds
v_mfma_f32_32x32x16_bf16 v[80:95], v[24:27], a[56:59], v[80:95]
buffer_load_dwordx4 v3, s[36:39], s52 offen offset:1024  lds
s_add_u32 s52, s52, 65536
s_cmp_ge_u32 s52, 1835008
s_cselect_b32 s93, 1835008, 0
s_sub_u32 s52, s52, s93
s_waitcnt vmcnt(12)
v_mfma_f32_32x32x16_bf16 v[96:111], v[20:23], a[60:63], v[96:111]
ds_read_b64_tr_b16 v[12:13], v6 offset:18432
ds_read_b64_tr_b16 v[14:15], v6 offset:18944
v_mfma_f32_32x32x16_bf16 v[112:127], v[24:27], a[60:63], v[112:127]
ds_read_b64_tr_b16 v[16:17], v7 offset:18432
ds_read_b64_tr_b16 v[18:19], v7 offset:18944
s_waitcnt lgkmcnt(4)
v_mfma_f32_32x32x16_bf16 v[64:79], v[28:31], a[64:67], v[64:79]
s_add_u32 m0, s29, 32768
s_nop 0
buffer_load_dwordx4 v2, s[36:39], s52 offen  lds
v_mfma_f32_32x32x16_bf16 v[80:95], v[32:35], a[64:67], v[80:95]
buffer_load_dwordx4 v3, s[36:39], s52 offen offset:1024  lds
s_add_u32 s52, s52, 65536
s_cmp_ge_u32 s52, 1835008
s_cselect_b32 s93, 1835008, 0
s_sub_u32 s52, s52, s93
s_waitcnt vmcnt(12)
v_mfma_f32_32x32x16_bf16 v[96:111], v[28:31], a[68:71], v[96:111]
ds_read_b64_tr_b16 v[20:21], v6 offset:20480
ds_read_b64_tr_b16 v[22:23], v6 offset:20992
v_mfma_f32_32x32x16_bf16 v[112:127], v[32:35], a[68:71], v[112:127]
ds_read_b64_tr_b16 v[24:25], v7 offset:20480
ds_read_b64_tr_b16 v[26:27], v7 offset:20992
s_waitcnt lgkmcnt(4)
v_mfma_f32_32x32x16_bf16 v[64:79], v[12:15], a[72:75], v[64:79]
s_add_u32 m0, s29, 34816
s_nop 0
buffer_load_dwordx4 v2, s[36:39], s52 offen  lds
v_mfma_f32_32x32x16_bf16 v[80:95], v[16:19], a[72:75], v[80:95]
buffer_load_dwordx4 v3, s[36:39], s52 offen offset:1024  lds
s_add_u32 s52, s52, 65536
s_cmp_ge_u32 s52, 1835008
s_cselect_b32 s93, 1835008, 0
s_sub_u32 s52, s52, s93
s_waitcnt vmcnt(12)
v_mfma_f32_32x32x16_bf16 v[96:111], v[12:15], a[76:79], v[96:111]
ds_read_b64_tr_b16 v[28:29], v6 offset:22528
ds_read_b64_tr_b16 v[30:31], v6 offset:23040
v_mfma_f32_32x32x16_bf16 v[112:127], v[16:19], a[76:79], v[112:127]
ds_read_b64_tr_b16 v[32:33], v7 offset:22528
ds_read_b64_tr_b16 v[34:35], v7 offset:23040
s_waitcnt lgkmcnt(4)
v_mfma_f32_32x32x16_bf16 v[64:79], v[20:23], a[80:83], v[64:79]
global_load_dword v62, v63, s[24:25] sc1
s_add_u32 m0, s29, 0
s_nop 0
buffer_load_dwordx4 v2, s[36:39], s52 offen  lds
v_mfma_f32_32x32x16_bf16 v[80:95], v[24:27], a[80:83], v[80:95]
buffer_load_dwordx4 v3, s[36:39], s52 offen offset:1024  lds
s_add_u32 s52, s52, 65536
s_cmp_ge_u32 s52, 1835008
s_cselect_b32 s93, 1835008, 0
s_sub_u32 s52, s52, s93
s_waitcnt vmcnt(13)
v_mfma_f32_32x32x16_bf16 v[96:111], v[20:23], a[84:87], v[96:111]
ds_read_b64_tr_b16 v[12:13], v6 offset:24576
ds_read_b64_tr_b16 v[14:15], v6 offset:25088
v_mfma_f32_32x32x16_bf16 v[112:127], v[24:27], a[84:87], v[112:127]
ds_read_b64_tr_b16 v[16:17], v7 offset:24576
ds_read_b64_tr_b16 v[18:19], v7 offset:25088
s_waitcnt lgkmcnt(4)
v_mfma_f32_32x32x16_bf16 v[64:79], v[28:31], a[88:91], v[64:79]
s_add_u32 m0, s29, 2048
s_nop 0
buffer_load_dwordx4 v2, s[36:39], s52 offen  lds
v_mfma_f32_32x32x16_bf16 v[80:95], v[32:35], a[88:91], v[80:95]
buffer_load_dwordx4 v3, s[36:39], s52 offen offset:1024  lds
s_add_u32 s52, s52, 65536
s_cmp_ge_u32 s52, 1835008
s_cselect_b32 s93, 1835008, 0
s_sub_u32 s52, s52, s93
s_waitcnt vmcnt(13)
v_mfma_f32_32x32x16_bf16 v[96:111], v[28:31], a[92:95], v[96:111]
ds_read_b64_tr_b16 v[20:21], v6 offset:26624
ds_read_b64_tr_b16 v[22:23], v6 offset:27136
v_mfma_f32_32x32x16_bf16 v[112:127], v[32:35], a[92:95], v[112:127]
ds_read_b64_tr_b16 v[24:25], v7 offset:26624
ds_read_b64_tr_b16 v[26:27], v7 offset:27136
s_waitcnt lgkmcnt(4)
v_mfma_f32_32x32x16_bf16 v[64:79], v[12:15], a[96:99], v[64:79]
s_add_u32 m0, s29, 4096
s_nop 0
buffer_load_dwordx4 v2, s[36:39], s52 offen  lds
v_mfma_f32_32x32x16_bf16 v[80:95], v[16:19], a[96:99], v[80:95]
buffer_load_dwordx4 v3, s[36:39], s52 offen offset:1024  lds
s_add_u32 s52, s52, 65536
s_cmp_ge_u32 s52, 1835008
s_cselect_b32 s93, 1835008, 0
s_sub_u32 s52, s52, s93
s_waitcnt vmcnt(13)
v_mfma_f32_32x32x16_bf16 v[96:111], v[12:15], a[100:103], v[96:111]
ds_read_b64_tr_b16 v[28:29], v6 offset:28672
ds_read_b64_tr_b16 v[30:31], v6 offset:29184
v_mfma_f32_32x32x16_bf16 v[112:127], v[16:19], a[100:103], v[112:127]
ds_read_b64_tr_b16 v[32:33], v7 offset:28672
ds_read_b64_tr_b16 v[34:35], v7 offset:29184
s_waitcnt lgkmcnt(4)
v_mfma_f32_32x32x16_bf16 v[64:79], v[20:23], a[104:107], v[64:79]
s_add_u32 m0, s29, 6144
s_nop 0
buffer_load_dwordx4 v2, s[36:39], s52 offen  lds
v_mfma_f32_32x32x16_bf16 v[80:95], v[24:27], a[104:107], v[80:95]
buffer_load_dwordx4 v3, s[36:39], s52 offen offset:1024  lds
s_add_u32 s52, s52, 65536
s_cmp_ge_u32 s52, 1835008
s_cselect_b32 s93, 1835008, 0
s_sub_u32 s52, s52, s93
s_waitcnt vmcnt(13)
v_mfma_f32_32x32x16_bf16 v[96:111], v[20:23], a[108:111], v[96:111]
ds_read_b64_tr_b16 v[12:13], v6 offset:30720
ds_read_b64_tr_b16 v[14:15], v6 offset:31232
v_mfma_f32_32x32x16_bf16 v[112:127], v[24:27], a[108:111], v[112:127]
ds_read_b64_tr_b16 v[16:17], v7 offset:30720
ds_read_b64_tr_b16 v[18:19], v7 offset:31232
s_waitcnt lgkmcnt(4)
v_mfma_f32_32x32x16_bf16 v[64:79], v[28:31], a[112:115], v[64:79]
s_add_u32 m0, s29, 8192
s_nop 0
buffer_load_dwordx4 v2, s[36:39], s52 offen  lds
v_mfma_f32_32x32x16_bf16 v[80:95], v[32:35], a[112:115], v[80:95]
buffer_load_dwordx4 v3, s[36:39], s52 offen offset:1024  lds
s_add_u32 s52, s52, 65536
s_cmp_ge_u32 s52, 1835008
s_cselect_b32 s93, 1835008, 0
s_sub_u32 s52, s52, s93
s_waitcnt vmcnt(13)
v_mfma_f32_32x32x16_bf16 v[96:111], v[28:31], a[116:119], v[96:111]
ds_read_b64_tr_b16 v[20:21], v6 offset:32768
ds_read_b64_tr_b16 v[22:23], v6 offset:33280
v_mfma_f32_32x32x16_bf16 v[112:127], v[32:35], a[116:119], v[112:127]
ds_read_b64_tr_b16 v[24:25], v7 offset:32768
ds_read_b64_tr_b16 v[26:27], v7 offset:33280
s_waitcnt lgkmcnt(4)
v_mfma_f32_32x32x16_bf16 v[64:79], v[12:15], a[120:123], v[64:79]
s_add_u32 m0, s29, 10240
s_nop 0
buffer_load_dwordx4 v2, s[36:39], s52 offen  lds
v_mfma_f32_32x32x16_bf16 v[80:95], v[16:19], a[120:123], v[80:95]
buffer_load_dwordx4 v3, s[36:39], s52 offen offset:1024  lds
s_add_u32 s52, s52, 65536
s_cmp_ge_u32 s52, 1835008
s_cselect_b32 s93, 1835008, 0
s_sub_u32 s52, s52, s93
s_waitcnt vmcnt(13)
v_mfma_f32_32x32x16_bf16 v[96:111], v[12:15], a[124:127], v[96:111]
ds_read_b64_tr_b16 v[28:29], v6 offset:34816
ds_read_b64_tr_b16 v[30:31], v6 offset:35328
v_mfma_f32_32x32x16_bf16 v[112:127], v[16:19], a[124:127], v[112:127]
ds_read_b64_tr_b16 v[32:33], v7 offset:34816
ds_read_b64_tr_b16 v[34:35], v7 offset:35328
s_waitcnt lgkmcnt(4)
v_mfma_f32_32x32x16_bf16 v[64:79], v[20:23], a[128:131], v[64:79]
s_add_u32 m0, s29, 12288
s_nop 0
buffer_load_dwordx4 v2, s[36:39], s52 offen  lds
v_mfma_f32_32x32x16_bf16 v[80:95], v[24:27], a[128:131], v[80:95]
buffer_load_dwordx4 v3, s[36:39], s52 offen offset:1024  lds
s_add_u32 s52, s52, 65536
s_cmp_ge_u32 s52, 1835008
s_cselect_b32 s93, 1835008, 0
s_sub_u32 s52, s52, s93
s_waitcnt vmcnt(12)
v_mfma_f32_32x32x16_bf16 v[96:111], v[20:23], a[132:135], v[96:111]
ds_read_b64_tr_b16 v[12:13], v6 offset:0
ds_read_b64_tr_b16 v[14:15], v6 offset:512
v_mfma_f32_32x32x16_bf16 v[112:127], v[24:27], a[132:135], v[112:127]
ds_read_b64_tr_b16 v[16:17], v7 offset:0
ds_read_b64_tr_b16 v[18:19], v7 offset:512
s_waitcnt lgkmcnt(4)
v_mfma_f32_32x32x16_bf16 v[64:79], v[28:31], a[136:139], v[64:79]
s_add_u32 m0, s29, 14336
s_nop 0
buffer_load_dwordx4 v2, s[36:39], s52 offen  lds
v_mfma_f32_32x32x16_bf16 v[80:95], v[32:35], a[136:139], v[80:95]
buffer_load_dwordx4 v3, s[36:39], s52 offen offset:1024  lds
s_add_u32 s52, s52, 65536
s_cmp_ge_u32 s52, 1835008
s_cselect_b32 s93, 1835008, 0
s_sub_u32 s52, s52, s93
s_waitcnt vmcnt(12)
v_mfma_f32_32x32x16_bf16 v[96:111], v[28:31], a[140:143], v[96:111]
ds_read_b64_tr_b16 v[20:21], v6 offset:2048
ds_read_b64_tr_b16 v[22:23], v6 offset:2560
v_mfma_f32_32x32x16_bf16 v[112:127], v[32:35], a[140:143], v[112:127]
ds_read_b64_tr_b16 v[24:25], v7 offset:2048
ds_read_b64_tr_b16 v[26:27], v7 offset:2560
s_waitcnt lgkmcnt(4)
v_mfma_f32_32x32x16_bf16 v[64:79], v[12:15], a[144:147], v[64:79]
s_add_u32 m0, s29, 16384
s_nop 0
buffer_load_dwordx4 v2, s[36:39], s52 offen  lds
v_mfma_f32_32x32x16_bf16 v[80:95], v[16:19], a[144:147], v[80:95]
buffer_load_dwordx4 v3, s[36:39], s52 offen offset:1024  lds
s_add_u32 s52, s52, 65536
s_cmp_ge_u32 s52, 1835008
s_cselect_b32 s93, 1835008, 0
s_sub_u32 s52, s52, s93
s_waitcnt vmcnt(12)
v_mfma_f32_32x32x16_bf16 v[96:111], v[12:15], a[148:151], v[96:111]
ds_read_b64_tr_b16 v[28:29], v6 offset:4096
ds_read_b64_tr_b16 v[30:31], v6 offset:4608
v_mfma_f32_32x32x16_bf16 v[112:127], v[16:19], a[148:151], v[112:127]
ds_read_b64_tr_b16 v[32:33], v7 offset:4096
ds_read_b64_tr_b16 v[34:35], v7 offset:4608
s_waitcnt lgkmcnt(4)
v_mfma_f32_32x32x16_bf16 v[64:79], v[20:23], a[152:155], v[64:79]
s_add_u32 m0, s29, 18432
s_nop 0
buffer_load_dwordx4 v2, s[36:39], s52 offen  lds
v_mfma_f32_32x32x16_bf16 v[80:95], v[24:27], a[152:155], v[80:95]
buffer_load_dwordx4 v3, s[36:39], s52 offen offset:1024  lds
s_add_u32 s52, s52, 65536
s_cmp_ge_u32 s52, 1835008
s_cselect_b32 s93, 1835008, 0
s_sub_u32 s52, s52, s93
s_waitcnt vmcnt(12)
v_mfma_f32_32x32x16_bf16 v[96:111], v[20:23], a[156:159], v[96:111]
ds_read_b64_tr_b16 v[12:13], v6 offset:6144
ds_read_b64_tr_b16 v[14:15], v6 offset:6656
v_mfma_f32_32x32x16_bf16 v[112:127], v[24:27], a[156:159], v[112:127]
ds_read_b64_tr_b16 v[16:17], v7 offset:6144
ds_read_b64_tr_b16 v[18:19], v7 offset:6656
s_waitcnt lgkmcnt(4)
v_mfma_f32_32x32x16_bf16 v[64:79], v[28:31], a[160:163], v[64:79]
s_waitcnt vmcnt(20)
s_mov_b32 s57, 0
L_y_poll_28:
v_cmp_eq_u32 vcc, s26, v62
s_nop 4
s_cmp_eq_u64 vcc, -1
s_cbranch_scc1 L_y_ok_27
global_load_dword v62, v63, s[24:25] sc1
s_waitcnt vmcnt(0)
s_add_u32 s57, s57, 1
s_cmp_lt_u32 s57, 262144
s_cbranch_scc1 L_y_poll_28
L_y_ok_27:
global_load_ushort v61, v49, s[24:25] sc1
s_add_u32 m0, s29, 20480
s_nop 0
buffer_load_dwordx4 v4, s[44:47], s97 offen  lds
v_mfma_f32_32x32x16_bf16 v[80:95], v[32:35], a[160:163], v[80:95]
buffer_load_dwordx4 v5, s[44:47], s97 offen offset:1024  lds
s_add_u32 s97, s97, 262144
s_cmp_ge_u32 s97, 2097152
s_cselect_b32 s93, 2097152, 0
s_sub_u32 s97, s97, s93
s_waitcnt vmcnt(13)
v_mfma_f32_32x32x16_bf16 v[96:111], v[28:31], a[164:167], v[96:111]
ds_read_b64_tr_b16 v[20:21], v6 offset:8192
ds_read_b64_tr_b16 v[22:23], v6 offset:8704
v_mfma_f32_32x32x16_bf16 v[112:127], v[32:35], a[164:167], v[112:127]
ds_read_b64_tr_b16 v[24:25], v7 offset:8192
ds_read_b64_tr_b16 v[26:27], v7 offset:8704
s_waitcnt lgkmcnt(4)
v_mfma_f32_32x32x16_bf16 v[64:79], v[12:15], a[168:171], v[64:79]
s_add_u32 m0, s29, 22528
s_nop 0
buffer_load_dwordx4 v4, s[44:47], s97 offen  lds
v_mfma_f32_32x32x16_bf16 v[80:95], v[16:19], a[168:171], v[80:95]
buffer_load_dwordx4 v5, s[44:47], s97 offen offset:1024  lds
s_add_u32 s97, s97, 262144
s_cmp_ge_u32 s97, 2097152
s_cselect_b32 s93, 2097152, 0
s_sub_u32 s97, s97, s93
s_waitcnt vmcnt(13)
v_mfma_f32_32x32x16_bf16 v[96:111], v[12:15], a[172:175], v[96:111]
ds_read_b64_tr_b16 v[28:29], v6 offset:10240
ds_read_b64_tr_b16 v[30:31], v6 offset:10752
v_mfma_f32_32x32x16_bf16 v[112:127], v[16:19], a[172:175], v[112:127]
ds_read_b64_tr_b16 v[32:33], v7 offset:10240
ds_read_b64_tr_b16 v[34:35], v7 offset:10752
s_waitcnt lgkmcnt(4)
v_mfma_f32_32x32x16_bf16 v[64:79], v[20:23], a[176:179], v[64:79]
s_add_u32 m0, s29, 24576
s_nop 0
buffer_load_dwordx4 v4, s[44:47], s97 offen  lds
v_mfma_f32_32x32x16_bf16 v[80:95], v[24:27], a[176:179], v[80:95]
buffer_load_dwordx4 v5, s[44:47], s97 offen offset:1024  lds
s_add_u32 s97, s97, 262144
s_cmp_ge_u32 s97, 2097152
s_cselect_b32 s93, 2097152, 0
s_sub_u32 s97, s97, s93
s_waitcnt vmcnt(13)
v_mfma_f32_32x32x16_bf16 v[96:111], v[20:23], a[180:183], v[96:111]
ds_read_b64_tr_b16 v[12:13], v6 offset:12288
ds_read_b64_tr_b16 v[14:15], v6 offset:12800
v_mfma_f32_32x32x16_bf16 v[112:127], v[24:27], a[180:183], v[112:127]
ds_read_b64_tr_b16 v[16:17], v7 offset:12288
ds_read_b64_tr_b16 v[18:19], v7 offset:12800
s_waitcnt lgkmcnt(4)
v_mfma_f32_32x32x16_bf16 v[64:79], v[28:31], a[184:187], v[64:79]
s_add_u32 m0, s29, 26624
s_nop 0
buffer_load_dwordx4 v4, s[44:47], s97 offen  lds
v_mfma_f32_32x32x16_bf16 v[80:95], v[32:35], a[184:187], v[80:95]
buffer_load_dwordx4 v5, s[44:47], s97 offen offset:1024  lds
s_add_u32 s97, s97, 262144
s_cmp_ge_u32 s97, 2097152
s_cselect_b32 s93, 2097152, 0
s_sub_u32 s97, s97, s93
s_waitcnt vmcnt(13)
v_mfma_f32_32x32x16_bf16 v[96:111], v[28:31], a[188:191], v[96:111]
ds_read_b64_tr_b16 v[20:21], v6 offset:14336
ds_read_b64_tr_b16 v[22:23], v6 offset:14848
v_mfma_f32_32x32x16_bf16 v[112:127], v[32:35], a[188:191], v[112:127]
ds_read_b64_tr_b16 v[24:25], v7 offset:14336
ds_read_b64_tr_b16 v[26:27], v7 offset:14848
s_waitcnt lgkmcnt(4)
v_mfma_f32_32x32x16_bf16 v[64:79], v[12:15], a[192:195], v[64:79]
s_add_u32 m0, s29, 28672
s_nop 0
buffer_load_dwordx4 v4, s[44:47], s97 offen  lds
v_mfma_f32_32x32x16_bf16 v[80:95], v[16:19], a[192:195], v[80:95]
buffer_load_dwordx4 v5, s[44:47], s97 offen offset:1024  lds
s_add_u32 s97, s97, 262144
s_cmp_ge_u32 s97, 2097152
s_cselect_b32 s93, 2097152, 0
s_sub_u32 s97, s97, s93
s_waitcnt vmcnt(13)
v_mfma_f32_32x32x16_bf16 v[96:111], v[12:15], a[196:199], v[96:111]
ds_read_b64_tr_b16 v[28:29], v6 offset:16384
ds_read_b64_tr_b16 v[30:31], v6 offset:16896
v_mfma_f32_32x32x16_bf16 v[112:127], v[16:19], a[196:199], v[112:127]
ds_read_b64_tr_b16 v[32:33], v7 offset:16384
ds_read_b64_tr_b16 v[34:35], v7 offset:16896
s_waitcnt lgkmcnt(4)
v_mfma_f32_32x32x16_bf16 v[64:79], v[20:23], a[200:203], v[64:79]
s_add_u32 m0, s29, 30720
s_nop 0
buffer_load_dwordx4 v4, s[44:47], s97 offen  lds
v_mfma_f32_32x32x16_bf16 v[80:95], v[24:27], a[200:203], v[80:95]
buffer_load_dwordx4 v5, s[44:47], s97 offen offset:1024  lds
s_add_u32 s97, s97, 262144
s_cmp_ge_u32 s97, 2097152
s_cselect_b32 s93, 2097152, 0
s_sub_u32 s97, s97, s93
s_waitcnt vmcnt(13)
v_mfma_f32_32x32x16_bf16 v[96:111], v[20:23], a[204:207], v[96:111]
ds_read_b64_tr_b16 v[12:13], v6 offset:18432
ds_read_b64_tr_b16 v[14:15], v6 offset:18944
v_mfma_f32_32x32x16_bf16 v[112:127], v[24:27], a[204:207], v[112:127]
ds_read_b64_tr_b16 v[16:17], v7 offset:18432
ds_read_b64_tr_b16 v[18:19], v7 offset:18944
s_waitcnt lgkmcnt(4)
v_mfma_f32_32x32x16_bf16 v[64:79], v[28:31], a[208:211], v[64:79]
s_add_u32 m0, s29, 32768
s_nop 0
buffer_load_dwordx4 v4, s[44:47], s97 offen  lds
v_mfma_f32_32x32x16_bf16 v[80:95], v[32:35], a[208:211], v[80:95]
buffer_load_dwordx4 v5, s[44:47], s97 offen offset:1024  lds
s_add_u32 s97, s97, 262144
s_cmp_ge_u32 s97, 2097152
s_cselect_b32 s93, 2097152, 0
s_sub_u32 s97, s97, s93
s_waitcnt vmcnt(12)
v_mfma_f32_32x32x16_bf16 v[96:111], v[28:31], a[212:215], v[96:111]
ds_read_b64_tr_b16 v[152:153], v8 offset:20480
ds_read_b64_tr_b16 v[154:155], v8 offset:20992
v_mfma_f32_32x32x16_bf16 v[112:127], v[32:35], a[212:215], v[112:127]
ds_read_b64_tr_b16 v[156:157], v9 offset:20480
ds_read_b64_tr_b16 v[158:159], v9 offset:20992
s_waitcnt lgkmcnt(4)
v_mfma_f32_32x32x16_bf16 v[64:79], v[12:15], a[216:219], v[64:79]
s_add_u32 m0, s29, 34816
s_nop 0
buffer_load_dwordx4 v4, s[44:47], s97 offen  lds
v_mfma_f32_32x32x16_bf16 v[80:95], v[16:19], a[216:219], v[80:95]
buffer_load_dwordx4 v5, s[44:47], s97 offen offset:1024  lds
s_add_u32 s97, s97, 262144
s_cmp_ge_u32 s97, 2097152
s_cselect_b32 s93, 2097152, 0
s_sub_u32 s97, s97, s93
s_waitcnt vmcnt(12)
v_mfma_f32_32x32x16_bf16 v[96:111], v[12:15], a[220:223], v[96:111]
ds_read_b64_tr_b16 v[160:161], v8 offset:22528
ds_read_b64_tr_b16 v[162:163], v8 offset:23040
v_mfma_f32_32x32x16_bf16 v[112:127], v[16:19], a[220:223], v[112:127]
ds_read_b64_tr_b16 v[164:165], v9 offset:22528
ds_read_b64_tr_b16 v[166:167], v9 offset:23040
s_waitcnt lgkmcnt(4)
v_mfma_f32_32x32x16_bf16 v[64:79], v[192:195], v[152:155], v[64:79]
v_mfma_f32_32x32x16_bf16 v[80:95], v[196:199], v[152:155], v[80:95]
s_waitcnt vmcnt(10)
v_mfma_f32_32x32x16_bf16 v[96:111], v[192:195], v[156:159], v[96:111]
ds_read_b64_tr_b16 v[144:145], v8 offset:24576
ds_read_b64_tr_b16 v[146:147], v8 offset:25088
v_mfma_f32_32x32x16_bf16 v[112:127], v[196:199], v[156:159], v[112:127]
ds_read_b64_tr_b16 v[148:149], v9 offset:24576
ds_read_b64_tr_b16 v[150:151], v9 offset:25088
s_waitcnt lgkmcnt(4)
v_mfma_f32_32x32x16_bf16 v[64:79], v[200:203], v[160:163], v[64:79]
v_mfma_f32_32x32x16_bf16 v[80:95], v[204:207], v[160:163], v[80:95]
s_waitcnt vmcnt(8)
v_mfma_f32_32x32x16_bf16 v[96:111], v[200:203], v[164:167], v[96:111]
ds_read_b64_tr_b16 v[152:153], v8 offset:26624
ds_read_b64_tr_b16 v[154:155], v8 offset:27136
v_mfma_f32_32x32x16_bf16 v[112:127], v[204:207], v[164:167], v[112:127]
ds_read_b64_tr_b16 v[156:157], v9 offset:26624
ds_read_b64_tr_b16 v[158:159], v9 offset:27136
s_waitcnt lgkmcnt(4)
v_mfma_f32_32x32x16_bf16 v[64:79], v[208:211], v[144:147], v[64:79]
v_mfma_f32_32x32x16_bf16 v[80:95], v[212:215], v[144:147], v[80:95]
s_waitcnt vmcnt(6)
v_mfma_f32_32x32x16_bf16 v[96:111], v[208:211], v[148:151], v[96:111]
ds_read_b64_tr_b16 v[160:161], v8 offset:28672
ds_read_b64_tr_b16 v[162:163], v8 offset:29184
v_mfma_f32_32x32x16_bf16 v[112:127], v[212:215], v[148:151], v[112:127]
ds_read_b64_tr_b16 v[164:165], v9 offset:28672
ds_read_b64_tr_b16 v[166:167], v9 offset:29184
s_waitcnt lgkmcnt(4)
v_mfma_f32_32x32x16_bf16 v[64:79], v[216:219], v[152:155], v[64:79]
v_mfma_f32_32x32x16_bf16 v[80:95], v[220:223], v[152:155], v[80:95]
s_waitcnt vmcnt(4)
v_mfma_f32_32x32x16_bf16 v[96:111], v[216:219], v[156:159], v[96:111]
ds_read_b64_tr_b16 v[144:145], v8 offset:30720
ds_read_b64_tr_b16 v[146:147], v8 offset:31232
v_mfma_f32_32x32x16_bf16 v[112:127], v[220:223], v[156:159], v[112:127]
ds_read_b64_tr_b16 v[148:149], v9 offset:30720
ds_read_b64_tr_b16 v[150:151], v9 offset:31232
s_waitcnt lgkmcnt(4)
v_mfma_f32_32x32x16_bf16 v[64:79], v[224:227], v[160:163], v[64:79]
v_mfma_f32_32x32x16_bf16 v[80:95], v[228:231], v[160:163], v[80:95]
s_waitcnt vmcnt(2)
v_mfma_f32_32x32x16_bf16 v[96:111], v[224:227], v[164:167], v[96:111]
ds_read_b64_tr_b16 v[152:153], v8 offset:32768
ds_read_b64_tr_b16 v[154:155], v8 offset:33280
v_mfma_f32_32x32x16_bf16 v[112:127], v[228:231], v[164:167], v[112:127]
ds_read_b64_tr_b16 v[156:157], v9 offset:32768
ds_read_b64_tr_b16 v[158:159], v9 offset:33280
s_waitcnt lgkmcnt(4)
v_mfma_f32_32x32x16_bf16 v[64:79], v[232:235], v[144:147], v[64:79]
v_mfma_f32_32x32x16_bf16 v[80:95], v[236:239], v[144:147], v[80:95]
s_waitcnt vmcnt(0)
v_mfma_f32_32x32x16_bf16 v[96:111], v[232:235], v[148:151], v[96:111]
ds_read_b64_tr_b16 v[160:161], v8 offset:34816
ds_read_b64_tr_b16 v[162:163], v8 offset:35328
v_mfma_f32_32x32x16_bf16 v[112:127], v[236:239], v[148:151], v[112:127]
ds_read_b64_tr_b16 v[164:165], v9 offset:34816
ds_read_b64_tr_b16 v[166:167], v9 offset:35328
s_waitcnt lgkmcnt(4)
v_mfma_f32_32x32x16_bf16 v[64:79], v[240:243], v[152:155], v[64:79]
v_mfma_f32_32x32x16_bf16 v[80:95], v[244:247], v[152:155], v[80:95]
v_mfma_f32_32x32x16_bf16 v[96:111], v[240:243], v[156:159], v[96:111]
v_mfma_f32_32x32x16_bf16 v[112:127], v[244:247], v[156:159], v[112:127]
s_waitcnt lgkmcnt(0)
v_mfma_f32_32x32x16_bf16 v[64:79], v[248:251], v[160:163], v[64:79]
v_mfma_f32_32x32x16_bf16 v[80:95], v[252:255], v[160:163], v[80:95]
v_mfma_f32_32x32x16_bf16 v[96:111], v[248:251], v[164:167], v[96:111]
v_mfma_f32_32x32x16_bf16 v[112:127], v[252:255], v[164:167], v[112:127]
v_lshlrev_b32 v44, 4, v1
v_add_u32 v45, s29, v44
s_xor_b32 s56, s3, 1
s_mul_i32 s56, s56, 36864
v_add_u32 v46, s56, v44
s_xor_b32 s56, s3, 2
s_mul_i32 s56, s56, 36864
v_add_u32 v47, s56, v44
s_xor_b32 s56, s3, 3
s_mul_i32 s56, s56, 36864
v_add_u32 v48, s56, v44
s_nop 7
ds_write_b128 v45, v[80:83] offset:0
ds_write_b128 v45, v[84:87] offset:1024
ds_write_b128 v45, v[88:91] offset:2048
ds_write_b128 v45, v[92:95] offset:3072
ds_write_b128 v45, v[96:99] offset:4096
ds_write_b128 v45, v[100:103] offset:5120
ds_write_b128 v45, v[104:107] offset:6144
ds_write_b128 v45, v[108:111] offset:7168
ds_write_b128 v45, v[112:115] offset:8192
ds_write_b128 v45, v[116:119] offset:9216
ds_write_b128 v45, v[120:123] offset:10240
ds_write_b128 v45, v[124:127] offset:11264
s_waitcnt lgkmcnt(0)
s_barrier
ds_read_b128 v[80:83], v46 offset:0
ds_read_b128 v[84:87], v46 offset:1024
ds_read_b128 v[88:91], v46 offset:2048
ds_read_b128 v[92:95], v46 offset:3072
ds_read_b128 v[96:99], v47 offset:4096
ds_read_b128 v[100:103], v47 offset:5120
ds_read_b128 v[104:107], v47 offset:6144
ds_read_b128 v[108:111], v47 offset:7168
ds_read_b128 v[112:115], v48 offset:8192
ds_read_b128 v[116:119], v48 offset:9216
ds_read_b128 v[120:123], v48 offset:10240
ds_read_b128 v[124:127], v48 offset:11264
s_waitcnt lgkmcnt(8)
v_add_f32 v128, v64, v80
v_add_f32 v129, v65, v81
v_add_f32 v130, v66, v82
v_add_f32 v131, v67, v83
v_add_f32 v132, v68, v84
v_add_f32 v133, v69, v85
v_add_f32 v134, v70, v86
v_add_f32 v135, v71, v87
v_add_f32 v136, v72, v88
v_add_f32 v137, v73, v89
v_add_f32 v138, v74, v90
v_add_f32 v139, v75, v91
v_add_f32 v140, v76, v92
v_add_f32 v141, v77, v93
v_add_f32 v142, v78, v94
v_add_f32 v143, v79, v95
s_waitcnt lgkmcnt(4)
v_add_f32 v128, v128, v96
v_add_f32 v129, v129, v97
v_add_f32 v130, v130, v98
v_add_f32 v131, v131, v99
v_add_f32 v132, v132, v100
v_add_f32 v133, v133, v101
v_add_f32 v134, v134, v102
v_add_f32 v135, v135, v103
v_add_f32 v136, v136, v104
v_add_f32 v137, v137, v105
v_add_f32 v138, v138, v106
v_add_f32 v139, v139, v107
v_add_f32 v140, v140, v108
v_add_f32 v141, v141, v109
v_add_f32 v142, v142, v110
v_add_f32 v143, v143, v111
s_waitcnt lgkmcnt(0)
v_add_f32 v128, v128, v112
v_add_f32 v129, v129, v113
v_add_f32 v130, v130, v114
v_add_f32 v131, v131, v115
v_add_f32 v132, v132, v116
v_add_f32 v133, v133, v117
v_add_f32 v134, v134, v118
v_add_f32 v135, v135, v119
v_add_f32 v136, v136, v120
v_add_f32 v137, v137, v121
v_add_f32 v138, v138, v122
v_add_f32 v139, v139, v123
v_add_f32 v140, v140, v124
v_add_f32 v141, v141, v125
v_add_f32 v142, v142, v126
v_add_f32 v143, v143, v127
v_lshlrev_b32 v176, 16, v176
v_lshlrev_b32 v61, 16, v61
v_fma_f32 v44, v61, 0.5, v176
v_fma_f32 v45, v61, -0.5, v176
v_pk_add_f32 v[128:129], v[128:129], v[44:45]
v_pk_add_f32 v[130:131], v[130:131], v[44:45]
v_pk_add_f32 v[132:133], v[132:133], v[44:45]
v_pk_add_f32 v[134:135], v[134:135], v[44:45]
v_pk_add_f32 v[136:137], v[136:137], v[44:45]
v_pk_add_f32 v[138:139], v[138:139], v[44:45]
v_pk_add_f32 v[140:141], v[140:141], v[44:45]
v_pk_add_f32 v[142:143], v[142:143], v[44:45]
s_nop 1
v_permlane32_swap_b32 v128, v132
v_permlane32_swap_b32 v129, v133
v_permlane32_swap_b32 v130, v134
v_permlane32_swap_b32 v131, v135
v_permlane32_swap_b32 v136, v140
v_permlane32_swap_b32 v137, v141
v_permlane32_swap_b32 v138, v142
v_permlane32_swap_b32 v139, v143
v_lshlrev_b32 v44, 16, v168
v_and_b32 v45, 0xffff0000, v168
v_add_f32 v128, v128, v44
v_add_f32 v129, v129, v45
v_cvt_pk_bf16_f32 v168, v128, v129
v_lshlrev_b32 v44, 16, v169
v_and_b32 v45, 0xffff0000, v169
v_add_f32 v130, v130, v44
v_add_f32 v131, v131, v45
v_cvt_pk_bf16_f32 v169, v130, v131
v_lshlrev_b32 v44, 16, v170
v_and_b32 v45, 0xffff0000, v170
v_add_f32 v132, v132, v44
v_add_f32 v133, v133, v45
v_cvt_pk_bf16_f32 v170, v132, v133
v_lshlrev_b32 v44, 16, v171
v_and_b32 v45, 0xffff0000, v171
v_add_f32 v134, v134, v44
v_add_f32 v135, v135, v45
v_cvt_pk_bf16_f32 v171, v134, v135
v_lshlrev_b32 v44, 16, v172
v_and_b32 v45, 0xffff0000, v172
v_add_f32 v136, v136, v44
v_add_f32 v137, v137, v45
v_cvt_pk_bf16_f32 v172, v136, v137
v_lshlrev_b32 v44, 16, v173
v_and_b32 v45, 0xffff0000, v173
v_add_f32 v138, v138, v44
v_add_f32 v139, v139, v45
v_cvt_pk_bf16_f32 v173, v138, v139
v_lshlrev_b32 v44, 16, v174
v_and_b32 v45, 0xffff0000, v174
v_add_f32 v140, v140, v44
v_add_f32 v141, v141, v45
v_cvt_pk_bf16_f32 v174, v140, v141
v_lshlrev_b32 v44, 16, v175
v_and_b32 v45, 0xffff0000, v175
v_add_f32 v142, v142, v44
v_add_f32 v143, v143, v45
v_cvt_pk_bf16_f32 v175, v142, v143
global_store_dwordx4 v50, v[168:171], s[20:21]
global_store_dwordx4 v50, v[172:175], s[20:21] offset:32
L_end_1:
s_endpgm
.section .rodata,"a"
.p2align 6
.amdhsa_kernel parallel_sum__spectral_gfnet__mixer_token_mlp__prompt_kernel
  .amdhsa_next_free_vgpr 512
  .amdhsa_next_free_sgpr 102
  .amdhsa_accum_offset 256
  .amdhsa_group_segment_fixed_size 0
  .amdhsa_kernarg_size 88
  .amdhsa_user_sgpr_count 2
  .amdhsa_user_sgpr_kernarg_segment_ptr 1
  .amdhsa_system_sgpr_workgroup_id_x 1
  .amdhsa_float_denorm_mode_32 3
.end_amdhsa_kernel
```
